```python
import torch

def _softmax(x, axis=-1):
    return torch.softmax(x, dim=axis)
def _gelu(x):
    return torch.nn.functional.gelu(x, approximate="tanh")
def _silu(x):
    return torch.nn.functional.silu(x)
def _sigmoid(x):
    return torch.sigmoid(x)
def _layernorm(x, axis=-1, eps=1e-5):
    m = x.mean(dim=axis, keepdim=True)
    v = x.var(dim=axis, keepdim=True, unbiased=False)
    return (x - m) / torch.sqrt(v + eps)
def _scatter_add(tgt, idx, src, axis=0):
    return tgt.clone().index_add_(axis, idx, src)
def _segment_sum(src, seg, n):
    out = torch.zeros((n,) + src.shape[1:], dtype=src.dtype)
    return out.index_add_(0, seg, src)
def _pad(x, pw):
    flat = tuple(v for pair in reversed(pw) for v in pair)
    return torch.nn.functional.pad(x, flat)

kernel_name = 'gated_mix__ssm_conv_s4d__linear_kernel_hedgehog__prompt'

def setup_inputs():

    _w = (lambda a: (lambda t: t.to(torch.bfloat16) if t.is_floating_point() else t)(torch.as_tensor(a)))
    def _A_setup():
        Bsz, L, D, N = 1, 2048, 640, 128
        return {
            "u": _w((lambda *s: torch.randn(*s, dtype=torch.bfloat16) * 0.05)(Bsz, L, D)),
            "log_A_real": _w((lambda *s: torch.randn(*s, dtype=torch.bfloat16) * 6.4)(D, N) * 0.5),
            "A_imag": _w((lambda *s: torch.randn(*s, dtype=torch.bfloat16) * 0.05)(D, N) * 3.14),
            "C_real": _w((lambda *s: torch.randn(*s, dtype=torch.bfloat16) * 0.2)(D, N) / N ** 0.5),
            "C_imag": _w((lambda *s: torch.randn(*s, dtype=torch.bfloat16) * 0.2)(D, N) / N ** 0.5),
            "log_dt": _w((lambda *s: torch.randn(*s, dtype=torch.bfloat16) * 0.05)(D) * 0.5 - 4.0),
            "D_skip": _w((lambda *s: torch.randn(*s, dtype=torch.bfloat16) * 0.05)(D)),
        }
    _A_in = _A_setup()

    def _B_setup():
        B, S, D, H = 1, 2048, 640, 32
        Dh = D // H
        return {
            "x": _w((lambda *s: torch.randn(*s, dtype=torch.bfloat16) * 0.05)(B, S, D)),
            "wqkv": _w((lambda *s: torch.randn(*s, dtype=torch.bfloat16) * 0.8)(D, 3 * D)),
            "w_phi": _w((lambda *s: torch.randn(*s, dtype=torch.bfloat16) * 0.8)(H, Dh, Dh) * (Dh ** -0.5)),
            "wo": _w((lambda *s: torch.randn(*s, dtype=torch.bfloat16) * 0.05)(D, D)),
        }
    _B_in = _B_setup()

    return {
        "A_u": _A_in["u"],
        "A_log_A_real": _A_in["log_A_real"],
        "A_A_imag": _A_in["A_imag"],
        "A_C_real": _A_in["C_real"],
        "A_C_imag": _A_in["C_imag"],
        "A_log_dt": _A_in["log_dt"],
        "A_D_skip": _A_in["D_skip"],
        "B_x": _B_in["x"],
        "B_wqkv": _B_in["wqkv"],
        "B_w_phi": _B_in["w_phi"],
        "B_wo": _B_in["wo"],
        "gate_w": _w((lambda *s: torch.randn(*s, dtype=torch.bfloat16) * 0.05)(640) * 16.0),
    }

def reference(A_u, A_log_A_real, A_A_imag, A_C_real, A_C_imag, A_log_dt, A_D_skip, B_x, B_wqkv, B_w_phi, B_wo, gate_w):
    def _A_ref(u, log_A_real, A_imag, C_real, C_imag, log_dt, D_skip):
        L = u.shape[1]
        dt = torch.exp(log_dt)
        A = -torch.exp(log_A_real) + 1j * A_imag
        C = (C_real + 1j * C_imag) * dt[:, None]
        pos = (lambda x, dt: x.to(dt))(torch.arange(L), log_dt.dtype)
        P = torch.exp((A * dt[:, None])[:, :, None] * pos[None, None, :])
        K = 2.0 * torch.einsum("dn,dnl->dl", C, P).real
        L2 = 2 * L
        u_t = (lambda x, *d: x.permute(*d))(u, 0, 2, 1)
        Kf = (lambda x, *a, **k: torch.fft.rfft(x.float(), *a, **k))(K, L2)
        Uf = (lambda x, *a, **k: torch.fft.rfft(x.float(), *a, **k))(u_t, L2)
        y = (lambda x, *a, **k: torch.fft.irfft(x, *a, **k).to(torch.bfloat16))(Uf * Kf[None, :, :], L2)[:, :, :L]
        y = (lambda x, *d: x.permute(*d))(y, 0, 2, 1)
        return y + u * D_skip[None, None, :]

    def _B_ref(x, wqkv, w_phi, wo):
        B, S, D = x.shape
        H = 32; Dh = D // H
        qkv = (lambda x, *d: x.permute(*d))((x @ wqkv).reshape(B, S, 3, H, Dh), 2, 0, 3, 1, 4)
        q, k, v = qkv[0], qkv[1], qkv[2]
        pq = torch.einsum("bhsd,hdf->bhsf", q, w_phi)
        pk = torch.einsum("bhsd,hdf->bhsf", k, w_phi)
        phi_q = torch.concatenate([_softmax(pq, axis=-1), _softmax(-pq, axis=-1)], axis=-1)
        phi_k = torch.concatenate([_softmax(pk, axis=-1), _softmax(-pk, axis=-1)], axis=-1)
        kv = torch.einsum("bhsf,bhsd->bhfd", phi_k, v)
        z  = torch.einsum("bhsf->bhf", phi_k)
        num = torch.einsum("bhqf,bhfd->bhqd", phi_q, kv)
        den = torch.einsum("bhqf,bhf->bhq", phi_q, z)[..., None] + 1e-6
        o = num / den
        return (lambda x, *d: x.permute(*d))(o, 0, 2, 1, 3).reshape(B, S, D) @ wo

    x = A_u
    g = _sigmoid((x * gate_w).sum(-1, keepdims=True))
    a = _A_ref(x, A_log_A_real, A_A_imag, A_C_real, A_C_imag, A_log_dt, A_D_skip)
    b = _B_ref(x, B_wqkv, B_w_phi, B_wo)
    return g * a + (1 - g) * b
```

```asm
; @launch grid=(424,1,1) block=(256,1,1) lds=81920
.amdgcn_target "amdgcn-amd-amdhsa--gfx950"
.text
.globl gated_mix__ssm_conv_s4d__linear_kernel_hedgehog__prompt_kernel
.p2align 12
.type gated_mix__ssm_conv_s4d__linear_kernel_hedgehog__prompt_kernel,@function
gated_mix__ssm_conv_s4d__linear_kernel_hedgehog__prompt_kernel:
    s_load_dwordx16 s[4:19], s[0:1], 0
    s_load_dwordx8 s[20:27], s[0:1], 64
    s_load_dwordx4 s[28:31], s[0:1], 96
    s_load_dwordx2 s[32:33], s[0:1], 112
    v_lshrrev_b32_e64 v1, 6, v0
    s_cmp_ge_u32 s2, 168
    v_readfirstlane_b32 s3, v1
    s_cbranch_scc1 L_B
    s_setprio 3
    s_cmp_ge_u32 s2, 8
    s_cbranch_scc1 L_A
    s_getpc_b64 s[60:61]
L_pc:
    v_lshlrev_b32_e64 v2, 7, v0
    v_min_u32 v2, L_codeend-L_pc-4, v2
    global_load_dword v3, v2, s[60:61]
    s_or_b32 s60, s2, s3
    s_cbranch_scc0 L_ep
L_exit:
    s_endpgm
L_A:
    s_sub_u32 s60, s2, 8
    s_lshl_b32 s63, s60, 2
    s_add_u32 s63, s63, s3
    s_mul_i32 s68, s3, 20480
    v_and_b32_e64 v1, 63, v0
    v_lshlrev_b32 v5, 2, v1
    s_lshl_b32 s64, s63, 8
    v_add_u32 v3, s64, v5
    s_and_b32 s67, s63, 0xfffffffe
    s_lshl_b32 s67, s67, 1
    s_waitcnt lgkmcnt(0)
    s_load_dword s70, s[14:15], s67
    s_load_dword s71, s[16:17], s67
    s_load_dwordx2 s[34:35], s[32:33], 196608
    global_load_dword v8, v3, s[6:7] nt
    global_load_dword v9, v3, s[8:9] nt
    global_load_dword v10, v3, s[10:11] nt
    global_load_dword v11, v3, s[12:13] nt
    s_branch L_A2
    s_nop 0
L_B:
    s_cmp_ge_u32 s2, 424
    s_cbranch_scc1 L_exit
    s_setprio 2
    s_sub_u32 s64, s2, 168
    s_bfe_u32 s62, s64, 0x10002
    s_and_b32 s60, s64, 3
    s_lshl_b32 s67, s3, 10
    s_add_u32 s100, s64, 160
    s_bfe_u32 s49, s100, 0x50003
    s_bfe_u32 s100, s100, 0x60002
    s_mul_i32 s72, s100, 61440
    s_add_u32 s72, s72, 1280
    s_sub_u32 s65, s100, 40
    s_mul_i32 s66, s65, 122880
    s_movk_i32 s50, 80
    s_cmp_ge_u32 s49, 20
    s_cselect_b32 s100, s65, s100
    s_cselect_b32 s72, s66, s72
    s_cselect_b32 s66, 3840, s50
    v_bfe_u32 v2, v0, 3, 4
    v_lshrrev_b32 v3, 4, v0
    v_xor_b32 v3, v3, v0
    v_and_b32 v3, 7, v3
    v_mul_u32_u24 v2, 240, v2
    v_lshrrev_b32_e64 v4, 7, v0
    v_mad_u32_u24 v2, v4, s66, v2
    v_add_lshl_u32 v80, v2, v3, 4
    s_mul_i32 s65, s60, 320
    s_and_b32 s65, s65, 0xffffff80
    s_add_u32 s72, s72, s65
    s_waitcnt lgkmcnt(0)
    s_mov_b32 s40, s20
    s_mov_b32 s41, s21
    s_mov_b32 s42, 2457600
    s_mov_b32 s43, 0x20000
    s_cmp_ge_u32 s49, 30
    s_cbranch_scc1 L_e0
    s_add_u32 m0, s67, 0
    s_add_u32 s65, s72, 0
    buffer_load_dwordx4 v80, s[40:43], s65 offen nt lds
    s_add_u32 m0, s67, 4096
    s_add_u32 s65, s72, 128
    buffer_load_dwordx4 v80, s[40:43], s65 offen nt lds
    s_add_u32 m0, s67, 8192
    s_add_u32 s65, s72, 256
    buffer_load_dwordx4 v80, s[40:43], s65 offen nt lds
L_e0:
    s_lshl_b32 s101, s60, 2
    s_add_u32 s101, s101, s3
    s_bfe_u32 s65, s64, 0x20003
    s_lshr_b32 s63, s64, 5
    s_sub_u32 s63, 7, s63
    s_lshl_b32 s60, s60, 2
    s_add_u32 s60, s60, s65
    s_lshl_b32 s61, s62, 3
    s_add_u32 s61, s61, s63
    s_cmp_eq_u32 s62, 0
    s_mov_b32 s50, 0x75319951
    s_cselect_b32 s50, 0x64208840, s50
    s_lshl_b32 s66, s63, 2
    s_lshr_b32 s50, s50, s66
    s_and_b32 s50, s50, 15
    s_mul_i32 s65, s65, 3
    s_add_u32 s50, s50, s65
    s_sub_u32 s65, s50, 10
    s_min_u32 s50, s50, s65
    v_bfe_u32 v2, v0, 3, 3
    v_lshl_add_u32 v2, v1, 5, v2
    v_mul_u32_u24 v8, 1280, v2
    v_bfe_u32 v2, v0, 4, 2
    v_and_b32 v3, 7, v0
    v_xor_b32 v2, v2, v3
    s_mul_i32 s65, s60, 163840
    v_lshl_add_u32 v8, v2, 4, v8
    v_add_u32 v8, s65, v8
    v_xor_b32 v9, 64, v8
    v_add_u32 v9, 9216, v9
    s_lshl_b32 s68, s3, 13
    s_lshl_b32 s69, s50, 7
    s_mul_i32 s70, s50, 10240
    s_add_u32 s70, s70, s67
    s_mul_i32 s71, s50, 6144
    s_add_u32 s71, s71, s67
    s_mov_b32 s48, 0x3fb8aa3b
    v_and_b32 v55, 63, v0
    v_lshlrev_b32 v54, 4, v55
    v_lshlrev_b32_e64 v55, 3, v55
    s_mov_b32 s36, s4
    s_mov_b32 s37, s5
    s_mov_b32 s38, 2621440
    s_mov_b32 s39, 0x20000
    s_mov_b32 s52, s24
    s_mov_b32 s53, s25
    s_mov_b32 s54, 819200
    s_mov_b32 s55, 0x20000
    s_and_b32 s65, s100, 1
    s_lshl_b32 s65, s65, 4
    s_cmp_ge_u32 s49, 20
    s_cselect_b32 s65, 32, s65
    s_add_u32 s18, s101, s65
    s_lshl_b32 s18, s18, 8
    s_add_u32 s20, s50, 0
    s_sub_u32 s65, s20, 10
    s_min_u32 s20, s20, s65
    s_lshl_b32 s25, s20, 8
    s_add_u32 s25, s25, 14336
    s_lshl_b32 s51, s3, 3
    s_xor_b32 s65, s63, 7
    s_add_u32 s51, s51, s65
    s_cmp_ge_u32 s51, 5
    s_cselect_b32 s15, 1, s60
    s_sub_u32 s21, s49, 20
    s_cmp_lt_u32 s3, 2
    s_nop 0
    s_cselect_b32 s21, 99, s21
    s_cmp_ge_u32 s21, 10
    s_cbranch_scc1 L_rp1
    s_lshl_b32 s14, s100, 3
    s_and_b32 s8, s101, 4
    s_add_u32 s14, s14, s8
    s_lshr_b32 s8, s101, 3
    s_lshl_b32 s8, s8, 1
    s_add_u32 s14, s14, s8
    s_and_b32 s8, s3, 1
    s_add_u32 s14, s14, s8
    s_lshr_b32 s8, s14, 3
    s_mul_i32 s9, s8, 52
    s_lshr_b32 s9, s9, 8
    s_and_b32 s13, s14, 4
    s_mul_i32 s72, s13, 102400
    s_mul_i32 s13, s13, 160
    s_mul_i32 s12, s8, 5120
    s_add_u32 s72, s72, s12
    s_and_b32 s12, s14, 3
    s_lshl_b32 s4, s12, 8
    s_add_u32 s72, s72, s4
    s_add_u32 s72, s72, 1048576
    s_mul_i32 s4, s9, 5
    s_sub_u32 s8, s8, s4
    s_and_b32 s4, s12, 1
    s_mul_i32 s4, s4, 20
    s_lshr_b32 s5, s12, 1
    s_lshl_b32 s5, s5, 3
    s_add_u32 s4, s4, s5
    s_mul_i32 s5, s8, 40
    s_add_u32 s4, s4, s5
    s_mul_i32 s12, s12, 40
    s_add_u32 s12, s12, 16
    s_cmp_eq_u32 s8, 4
    s_cselect_b32 s4, s12, s4
    s_cselect_b32 s5, 20, 4
    s_mul_i32 s9, s9, 160
    s_add_u32 s4, s4, s9
    s_add_u32 s5, s5, s4
    s_mul_i32 s4, s4, 1280
    s_mul_i32 s5, s5, 1280
    s_add_u32 s4, s4, s13
    s_add_u32 s5, s5, s13
    s_sub_u32 s5, s5, 5120
    v_and_b32 v95, 63, v0
    s_mov_b64 exec, -1
    v_add_u32_e64 v92, 0, v95
    v_mul_u32_u24 v93, 205, v92
    v_lshrrev_b32_e64 v93, 13, v93
    v_mad_u32_u24 v92, v93, 40, v92
    s_add_u32 m0, s68, 0
    v_lshlrev_b32 v92, 4, v92
    buffer_load_dwordx4 v92, s[52:55], s4 offen nt lds
    s_mov_b64 exec, -1
    v_add_u32 v92, 64, v95
    v_mul_u32_u24 v93, 205, v92
    v_lshrrev_b32_e64 v93, 13, v93
    v_mad_u32_u24 v92, v93, 40, v92
    s_add_u32 m0, s68, 1024
    v_lshlrev_b32 v92, 4, v92
    buffer_load_dwordx4 v92, s[52:55], s4 offen nt lds
    s_mov_b64 exec, -1
    v_add_u32 v92, 128, v95
    v_mul_u32_u24 v93, 205, v92
    v_lshrrev_b32_e64 v93, 13, v93
    v_mad_u32_u24 v92, v93, 40, v92
    s_add_u32 m0, s68, 2048
    v_lshlrev_b32 v92, 4, v92
    s_mov_b32 exec_hi, 0
    buffer_load_dwordx4 v92, s[52:55], s4 offen nt lds
    s_not_b64 exec, exec
    buffer_load_dwordx4 v92, s[52:55], s5 offen nt lds
    s_mov_b64 exec, -1
    v_add_u32 v92, 192, v95
    v_mul_u32_u24 v93, 205, v92
    v_lshrrev_b32_e64 v93, 13, v93
    v_mad_u32_u24 v92, v93, 40, v92
    s_add_u32 m0, s68, 3072
    v_lshlrev_b32 v92, 4, v92
    buffer_load_dwordx4 v92, s[52:55], s5 offen nt lds
    s_mov_b64 exec, -1
    v_add_u32 v92, 256, v95
    v_mul_u32_u24 v93, 205, v92
    v_lshrrev_b32_e64 v93, 13, v93
    v_mad_u32_u24 v92, v93, 40, v92
    s_add_u32 m0, s68, 4096
    v_lshlrev_b32_e64 v92, 4, v92
    buffer_load_dwordx4 v92, s[52:55], s5 offen nt lds
L_rp1:
    s_load_dwordx2 s[34:35], s[32:33], 196608
    s_mov_b32 s44, s32
    s_mov_b32 s45, s33
    s_mov_b32 s46, 16777216
    s_mov_b32 s47, 0x20000
    s_mov_b32 s52, s26
    s_mov_b32 s53, s27
    s_mov_b32 s54, 1280
    s_mov_b32 s55, 0x20000
    s_and_b32 s65, s101, 4
    s_lshl_b32 s65, s65, 4
    s_mul_i32 s66, s3, 80
    s_add_u32 s65, s65, s66
    v_bfe_u32 v94, v0, 1, 1
    v_mad_u32_u24 v94, v94, 40, s65
    v_and_b32 v95, 1, v0
    v_bfe_u32 v92, v0, 4, 1
    v_bfe_u32 v93, v0, 2, 2
    v_lshl_add_u32 v92, v92, 3, v93
    v_bfe_u32 v91, v0, 5, 1
    v_and_b32_e64 v90, 0x30, v0
    s_lshl_b32 s65, s100, 6
    s_mov_b64 s[16:17], 0
    s_cmp_ge_u32 s49, 20
    s_cbranch_scc1 L_jq
    v_lshl_add_u32 v92, v95, 4, v92
    v_and_b32 v93, 0x1f0, v54
    v_lshl_add_u32 v84, v91, 3, v94
    v_add_u32 v85, 16, v84
    v_add_u32 v86, 32, v94
    v_lshl_add_u32 v24, v91, 10, v93
    v_add_u32 v25, 2048, v24
    v_add_u32 v26, 4096, v93
    s_lshr_b32 s65, s100, 1
    s_mul_i32 s19, s101, 20
    s_add_u32 s19, s19, s65
    s_mul_i32 s19, s19, 5120
    s_and_b32 s65, s100, 1
    s_lshl_b32 s65, s65, 9
    s_add_u32 s19, s19, s65
    s_add_u32 s19, s19, 13631488
    s_branch L_jj
    s_nop 0
L_jq:
    buffer_load_dwordx4 v[76:79], v90, s[52:55], s65 offen
    v_lshl_add_u32 v92, v91, 4, v92
    v_lshl_add_u32 v84, v95, 4, v94
    v_add_u32 v85, 8, v84
    v_add_u32 v86, 32, v84
    v_mov_b32_e64 v24, v54
    v_add_u32 v25, 1024, v54
    v_add_u32 v26, 2048, v54
    s_mul_i32 s19, s101, 20
    s_add_u32 s19, s19, s100
    s_mul_i32 s19, s19, 3072
    s_add_u32 s19, s19, 15728640
    s_mov_b32 s16, 0xf0f0f0f0
    s_mov_b32 s17, 0xf0f0f0f0
L_jj:
    v_bfe_u32 v93, v92, 1, 3
    v_lshlrev_b32 v93, 4, v93
    v_lshlrev_b32 v92, 7, v92
    v_lshrrev_b32_e64 v89, 7, v84
    v_and_b32 v88, 127, v84
    v_xor_b32_e64 v88, v88, v93
    v_lshl_add_u32 v89, v89, 12, v92
    v_add_u32 v16, v88, v89
    v_xor_b32 v17, 32, v16
    v_lshrrev_b32_e64 v89, 7, v85
    v_and_b32 v88, 127, v85
    v_xor_b32_e64 v88, v88, v93
    v_lshl_add_u32 v89, v89, 12, v92
    v_add_u32 v18, v88, v89
    v_xor_b32 v19, 32, v18
    v_lshrrev_b32_e64 v89, 7, v86
    v_and_b32 v88, 127, v86
    v_xor_b32_e64 v88, v88, v93
    v_lshl_add_u32 v89, v89, 12, v92
    v_add_u32 v20, v88, v89
    v_xor_b32 v21, 32, v20
    s_mov_b64 s[6:7], 1
    s_lshl_b32 s30, s61, 2
    s_add_u32 s30, s30, s3
    s_lshl_b32 s30, s30, 8
    s_add_u32 s30, s30, 28672
    s_lshl_b32 s31, s60, 1
    s_lshr_b32 s65, s3, 1
    s_add_u32 s31, s31, s65
    s_lshl_b32 s31, s31, 2
    s_lshr_b32 s65, s61, 2
    s_add_u32 s31, s31, s65
    s_lshl_b32 s31, s31, 8
    s_add_u32 s31, s31, 45056
    s_min_u32 s74, s3, 2
    s_lshl_b32 s74, s74, 4
    s_add_u32 s74, s74, s61
    s_cmp_eq_u32 s3, 3
    s_cselect_b32 s65, 8, 0
    s_xor_b32 s74, s74, s65
    s_lshl_b32 s74, s74, 8
    v_and_b32 v56, 15, v0
    v_lshrrev_b32 v57, 1, v56
    v_bfe_u32 v58, v0, 4, 2
    v_xor_b32 v57, v57, v58
    v_lshlrev_b32 v57, 4, v57
    v_lshl_add_u32 v10, v56, 7, v57
    v_add_u32 v10, s68, v10
    v_xor_b32 v11, 64, v10
    v_lshrrev_b32_e64 v57, 5, v0
    v_lshl_add_u32 v48, v57, 4, v56
    v_lshlrev_b32_e64 v48, 2, v48
    v_add_u32 v48, 80384, v48
    v_bfe_u32 v56, v0, 5, 1
    v_and_b32_e64 v57, 1, v0
    v_bfe_u32 v58, v0, 1, 1
    v_cmp_eq_u32 s[56:57], v57, v56
    v_mul_u32_u24 v50, 800, v56
    v_bfe_u32 v57, v0, 2, 2
    v_mad_u32_u24 v50, v57, 40, v50
    v_add_u32 v50, 77824, v50
    v_lshl_add_u32 v49, v58, 3, v50
    v_bfe_u32 v58, v0, 4, 1
    v_lshl_add_u32 v49, v58, 4, v49
    v_mov_b32 v59, 79424
    v_cndmask_b32 v49, v59, v49, s[56:57]
    v_lshlrev_b32_e64 v53, 1, v56
    v_lshl_add_u32 v53, v57, 2, v53
    v_mul_u32_u24 v53, 272, v53
    v_and_b32_e64 v57, 3, v0
    v_lshl_add_u32 v58, v58, 2, v57
    v_lshl_add_u32 v53, v58, 3, v53
    v_bfe_u32 v58, v0, 4, 2
    v_cmp_eq_u32 s[56:57], v57, v58
    v_add_u32 v50, 32, v50
    v_and_b32 v57, 31, v0
    v_lshrrev_b32_e64 v58, 6, v0
    v_cndmask_b32 v50, v59, v50, s[56:57]
    v_lshl_add_u32 v57, v58, 5, v57
    v_mul_u32_u24 v57, 272, v57
    v_mul_u32_u24 v59, 80, v56
    v_add_u32_e64 v51, v57, v59
    v_mad_u32_u24 v52, v56, 48, v57
    v_mad_u32_u24 v53, v58, 40, v53
    v_and_b32 v1, 31, v0
    v_add_u32 v2, 32, v1
    v_min_u32_e64 v2, 54, v2
    v_bfe_u32 v59, v0, 5, 1
    v_lshlrev_b32_e64 v56, 3, v59
    v_lshl_add_u32 v5, v1, 4, v56
    v_lshlrev_b32_e64 v56, 10, v59
    v_lshl_add_u32 v1, v1, 4, v56
    v_lshl_add_u32 v2, v2, 4, v56
    v_and_b32_e64 v56, 15, v0
    v_bfe_u32 v57, v0, 4, 1
    v_mad_i32_i24 v58, v57, -8, v56
    v_lshl_add_u32 v56, v59, 4, v56
    v_and_b32 v3, 1, v58
    v_lshlrev_b32 v3, 4, v3
    v_mov_b32 v4, 0x3f80
    v_lshlrev_b32 v3, v3, v4
    s_waitcnt lgkmcnt(0)
    s_add_u32 s34, s34, 0x7f4a7c15
    s_addc_u32 s35, s35, 0x9e3779b9
    s_lshl_b32 s8, s101, 2
    s_add_u32 s8, s8, s100
    s_lshl_b32 s8, s8, 8
    s_add_u32 s8, s8, 28672
    s_sub_u32 s9, s2, 264
    s_min_u32 s9, s9, 255
    s_lshl_b32 s65, s3, 8
    s_add_u32 s65, s65, s9
    s_lshl_b32 s9, s9, 8
    s_add_u32 s9, s9, 45056
    s_cmp_ge_u32 s49, 2
    s_cbranch_scc1 L_rp2
    s_atomic_swap_x2 s[34:35], s[32:33], s8
L_rp2:
    s_cmp_ge_u32 s65, 128
    s_cbranch_scc1 L_rp3
    s_atomic_swap_x2 s[34:35], s[32:33], s9
L_rp3:
    s_cmp_ge_u32 s49, 20
    s_cselect_b32 s65, 0, 1
    s_cmp_gt_u32 s100, s65
    s_cbranch_scc1 L_rp4
    s_atomic_swap_x2 s[34:35], s[32:33], s18
L_rp4:
    s_cmp_lg_u32 s15, 0
    s_cbranch_scc1 L_rp5
    s_atomic_swap_x2 s[34:35], s[32:33], s25
L_rp5:
    s_mov_b64 s[10:11], s[34:35]
    s_mov_b64 s[12:13], s[34:35]
    s_cmp_ge_u32 s49, 20
    s_waitcnt vmcnt(0)
    s_cbranch_scc0 L_jw
    s_waitcnt vmcnt(0)
L_jw:
    s_barrier
    s_cmp_ge_u32 s49, 30
    s_cbranch_scc1 L_rp6
    ds_read_b64_tr_b16 v[60:61], v16 offset:0
    ds_read_b64_tr_b16 v[62:63], v17 offset:512
    ds_read_b64_tr_b16 v[64:65], v18 offset:0
    ds_read_b64_tr_b16 v[66:67], v19 offset:512
    ds_read_b64_tr_b16 v[68:69], v20 offset:0
    ds_read_b64_tr_b16 v[70:71], v21 offset:512
    ds_read_b32 v92, v55
    ds_read_b32 v92, v55
    ds_read_b32 v92, v55
    ds_read_b32 v92, v55
    ds_read_b32 v92, v55
    ds_read_b32 v92, v55
    s_waitcnt lgkmcnt(6)
    s_nop 0
    buffer_store_dwordx4 v[60:63], v24, s[44:47], s19 offen sc1
    buffer_store_dwordx4 v[64:67], v25, s[44:47], s19 offen sc1
    v_cndmask_b32 v68, v68, v76, s[16:17]
    v_cndmask_b32 v69, v69, v77, s[16:17]
    v_cndmask_b32 v70, v70, v78, s[16:17]
    v_cndmask_b32 v71, v71, v79, s[16:17]
    buffer_store_dwordx4 v[68:71], v26, s[44:47], s19 offen sc1
L_rp6:
    s_cmp_ge_u32 s21, 10
    s_cbranch_scc1 L_rp7
    v_bfe_u32 v84, v0, 4, 2
    v_and_b32_e64 v85, 15, v0
    v_mul_u32_u24 v86, 160, v84
    v_add_u32_e64 v86, s68, v86
    v_lshl_add_u32 v87, v85, 1, v86
    v_lshl_add_u32 v86, v85, 3, v86
    v_mul_u32_u24 v84, 102400, v84
    v_lshl_add_u32 v84, v85, 4, v84
    s_mov_b32 s4, 0x05040100
    s_mov_b32 s5, 0x07060302
    ds_read_b64 v[192:193], v86 offset:0
    ds_read_u16 v208, v87 offset:128
    ds_read_b64 v[194:195], v86 offset:640
    ds_read_u16 v209, v87 offset:768
    ds_read_b64 v[196:197], v86 offset:1280
    ds_read_u16 v210, v87 offset:1408
    ds_read_b64 v[198:199], v86 offset:1920
    ds_read_u16 v211, v87 offset:2048
    ds_read_b64 v[200:201], v86 offset:2560
    ds_read_u16 v212, v87 offset:2688
    ds_read_b64 v[202:203], v86 offset:3200
    ds_read_u16 v213, v87 offset:3328
    ds_read_b64 v[204:205], v86 offset:3840
    ds_read_u16 v214, v87 offset:3968
    ds_read_b64 v[206:207], v86 offset:4480
    ds_read_u16 v215, v87 offset:4608
    ds_read_b32 v92, v55
    ds_read_b32 v92, v55
    ds_read_b32 v92, v55
    ds_read_b32 v92, v55
    s_waitcnt lgkmcnt(4)
    s_nop 0
    v_perm_b32 v224, v194, v192, s4
    v_perm_b32 v225, v198, v196, s4
    v_perm_b32 v226, v202, v200, s4
    v_perm_b32 v227, v206, v204, s4
    buffer_store_dwordx4 v[224:227], v84, s[44:47], s72 offen offset:0 sc1
    v_perm_b32 v228, v194, v192, s5
    v_perm_b32 v229, v198, v196, s5
    v_perm_b32 v230, v202, v200, s5
    v_perm_b32 v231, v206, v204, s5
    buffer_store_dwordx4 v[228:231], v84, s[44:47], s72 offen offset:1024 sc1
    v_perm_b32 v232, v195, v193, s4
    v_perm_b32 v233, v199, v197, s4
    v_perm_b32 v234, v203, v201, s4
    v_perm_b32 v235, v207, v205, s4
    buffer_store_dwordx4 v[232:235], v84, s[44:47], s72 offen offset:2048 sc1
    v_perm_b32 v236, v195, v193, s5
    v_perm_b32 v237, v199, v197, s5
    v_perm_b32 v238, v203, v201, s5
    v_perm_b32 v239, v207, v205, s5
    buffer_store_dwordx4 v[236:239], v84, s[44:47], s72 offen offset:3072 sc1
    v_lshl_or_b32 v240, v209, 16, v208
    v_lshl_or_b32 v241, v211, 16, v210
    v_lshl_or_b32 v242, v213, 16, v212
    v_lshl_or_b32 v243, v215, 16, v214
    s_add_u32 s72, s72, 4096
    buffer_store_dwordx4 v[240:243], v84, s[44:47], s72 offen sc1
L_rp7:
    s_barrier
    s_add_u32 m0, s68, 40960
    s_nop 0
    buffer_load_dwordx4 v8, s[36:39], s69 offen offset:0 lds
    buffer_load_dwordx4 v9, s[36:39], s69 offen offset:1024 lds
    s_add_u32 m0, s68, 43008
    s_add_u32 s64, s69, 20480
    s_add_u32 s69, s69, 128
    s_sub_u32 s66, s69, 1280
    s_min_u32 s69, s69, s66
    buffer_load_dwordx4 v8, s[36:39], s64 offen offset:0 lds
    buffer_load_dwordx4 v9, s[36:39], s64 offen offset:1024 lds
    v_lshrrev_b32_e64 v58, 1, v58
    v_cmp_eq_u32 s[56:57], 0, v58
    v_cmp_eq_u32 s[58:59], 1, v58
    s_lshr_b32 s73, s3, 1
    v_cndmask_b32 v44, 0, v3, s[56:57]
    v_cndmask_b32 v45, 0, v3, s[58:59]
    v_cmp_eq_u32 s[56:57], 2, v58
    v_cmp_eq_u32 s[58:59], 3, v58
    s_mul_i32 s73, s73, 1680
    v_cndmask_b32 v46, 0, v3, s[56:57]
    v_cndmask_b32 v47, 0, v3, s[58:59]
    s_mul_i32 s75, s3, 40
    s_add_u32 s73, s73, s75
    s_add_u32 s73, s73, 10240
    v_cmp_le_u32 s[56:57], 22, v56
    v_cmp_le_u32 s[58:59], 12, v56
    v_mul_u32_u24 v3, 80, v56
    v_mov_b32 v58, -1752
    v_cndmask_b32 v58, 0, v58, s[56:57]
    v_lshl_add_u32 v3, v57, 4, v3
    v_add_u32 v4, 808, v3
    v_add3_u32 v3, v3, v58, s73
    v_lshl_add_u32 v58, v56, 1, v57
    v_mul_u32_u24 v58, 80, v58
    v_subrev_u32 v58, 1888, v58
    v_cndmask_b32 v4, v4, v58, s[58:59]
    v_add_u32_e64 v4, s73, v4
    v_bfe_u32 v56, v0, 2, 1
    v_cmp_eq_u32 s[56:57], v56, v59
    v_bfe_u32 v57, v0, 3, 2
    v_and_b32_e64 v58, 3, v0
    v_lshl_add_u32 v57, v57, 2, v58
    v_mad_u32_u24 v57, v56, 22, v57
    v_mul_u32_u24 v57, 80, v57
    v_add_u32 v6, 10240, v57
    v_add_u32 v7, 11520, v57
    v_mov_b32 v58, 79424
    v_cndmask_b32 v6, v58, v6, s[56:57]
    v_cndmask_b32 v7, v58, v7, s[56:57]
    v_lshlrev_b32_e64 v57, 2, v0
    v_min_u32 v57, 700, v57
    v_add_u32 v57, 79424, v57
    v_mov_b32_e64 v58, 0
    ds_write_b32 v57, v58
    s_mov_b32 s56, s28
    s_mov_b32 s57, s29
    s_mov_b32 s58, 2621440
    s_mov_b32 s59, 0x20000
    s_waitcnt vmcnt(4)
    s_waitcnt lgkmcnt(0)
    s_barrier
    s_cmp_ge_u32 s49, 30
    s_cbranch_scc1 L_rp8
    s_mov_b64 s[10:11], 1
    s_atomic_add_x2 s[10:11], s[32:33], s18 glc
L_rp8:
    s_add_u32 m0, s68, 45056
    s_nop 0
    buffer_load_dwordx4 v8, s[36:39], s69 offen offset:0 lds
    buffer_load_dwordx4 v9, s[36:39], s69 offen offset:1024 lds
    s_add_u32 m0, s68, 47104
    s_add_u32 s64, s69, 20480
    s_add_u32 s69, s69, 128
    s_sub_u32 s66, s69, 1280
    s_min_u32 s69, s69, s66
    buffer_load_dwordx4 v8, s[36:39], s64 offen offset:0 lds
    buffer_load_dwordx4 v9, s[36:39], s64 offen offset:1024 lds
    s_mov_b32 s52, s22
    s_mov_b32 s53, s23
    s_mov_b32 s54, 25600
    s_mov_b32 s55, 0x20000
    s_mul_i32 s65, s3, 400
    s_add_u32 m0, s65, 77824
    s_mul_i32 s66, s61, 1600
    s_add_u32 s65, s65, s66
    s_mov_b64 exec, 0x1ffffff
    buffer_load_dwordx4 v54, s[52:55], s65 offen lds
    s_mov_b64 exec, -1
    s_mul_i32 s65, s61, 102400
    s_add_u32 s65, s65, 13631488
    s_add_u32 s40, s32, s65
    s_addc_u32 s41, s33, 0
    s_mov_b32 s42, 102400
    s_mul_i32 s65, s61, 61440
    s_add_u32 s65, s65, 15728640
    s_add_u32 s52, s32, s65
    s_addc_u32 s53, s33, 0
    s_mov_b32 s54, 61440
    v_bfe_u32 v81, v0, 4, 2
    v_bfe_u32 v80, v0, 2, 2
    v_lshl_add_u32 v81, v81, 3, v80
    v_bfe_u32 v82, v81, 1, 3
    v_bfe_u32 v83, v0, 1, 1
    v_xor_b32 v82, v82, v83
    v_lshlrev_b32 v82, 4, v82
    v_lshl_add_u32 v81, v81, 7, v82
    v_and_b32_e64 v82, 1, v0
    v_lshl_add_u32 v81, v82, 3, v81
    v_add_u32 v81, s68, v81
    v_lshlrev_b32 v80, 14, v80
    v_and_b32_e64 v82, 3, v0
    v_lshl_add_u32 v80, v82, 4, v80
    v_and_b32 v82, 0x30, v0
    v_lshl_add_u32 v80, v82, 2, v80
    s_lshl_b32 s65, s60, 2
    s_add_u32 s65, s65, s3
    s_lshl_b32 s65, s65, 8
    s_lshl_b32 s20, s20, 18
    s_add_u32 s20, s20, s65
    s_add_u32 s20, s20, 3145728
    v_xor_b32 v82, 32, v81
    v_xor_b32 v83, 64, v81
    v_xor_b32 v90, 96, v81
    s_mov_b64 exec, 0
    s_cmp_eq_u32 s3, 0
    s_cbranch_scc1 L_pageB0
    s_cmp_eq_u32 s3, 1
    s_cbranch_scc1 L_pageB1
    s_cmp_eq_u32 s3, 2
    s_cbranch_scc1 L_pageB2
    s_cmp_eq_u32 s3, 3
    s_cbranch_scc1 L_pageB3
L_warmB:
    s_mov_b64 exec, -1
    s_waitcnt vmcnt(7)
    ds_read_b128 v[96:99], v10 offset:40960
    ds_read_b128 v[104:107], v11 offset:40960
    s_waitcnt vmcnt(5)
    ds_read_b128 v[100:103], v10 offset:43008
    ds_read_b128 v[108:111], v11 offset:43008
    ds_read_b64_tr_b16 v[60:61], v81 offset:40960
    ds_read_b64_tr_b16 v[62:63], v82 offset:41472
    ds_read_b64_tr_b16 v[64:65], v82 offset:40960
    ds_read_b64_tr_b16 v[66:67], v81 offset:41472
    ds_read_b64_tr_b16 v[68:69], v83 offset:40960
    ds_read_b64_tr_b16 v[70:71], v90 offset:41472
    ds_read_b64_tr_b16 v[72:73], v90 offset:40960
    ds_read_b64_tr_b16 v[74:75], v83 offset:41472
    s_waitcnt lgkmcnt(0)
    s_cmp_lt_u32 s63, 3
    s_cbranch_scc1 L_rp9
    s_nop 0
    buffer_store_dwordx4 v[60:63], v80, s[44:47], s20 offen sc1
    s_add_u32 s20, s20, 65536
    buffer_store_dwordx4 v[64:67], v80, s[44:47], s20 offen sc1
    s_add_u32 s20, s20, 65536
    buffer_store_dwordx4 v[68:71], v80, s[44:47], s20 offen sc1
    s_add_u32 s20, s20, 65536
    buffer_store_dwordx4 v[72:75], v80, s[44:47], s20 offen sc1
L_rp9:
    s_add_u32 m0, s68, 40960
    s_nop 0
    buffer_load_dwordx4 v8, s[36:39], s69 offen offset:0 lds
    buffer_load_dwordx4 v9, s[36:39], s69 offen offset:1024 lds
    s_waitcnt vmcnt(5)
    ds_read_b128 v[112:115], v10 offset:45056
    ds_read_b128 v[120:123], v11 offset:45056
    s_add_u32 m0, s68, 43008
    s_add_u32 s64, s69, 20480
    s_add_u32 s69, s69, 128
    s_sub_u32 s66, s69, 1280
    s_min_u32 s69, s69, s66
    buffer_load_dwordx4 v8, s[36:39], s64 offen offset:0 lds
    buffer_load_dwordx4 v9, s[36:39], s64 offen offset:1024 lds
    s_waitcnt lgkmcnt(0)
    s_sub_u32 s10, s10, s34
    s_subb_u32 s11, s11, s35
    s_lshr_b32 s10, s10, 8
    s_or_b32 s10, s10, s11
    s_cbranch_scc1 L_slow10
L_back10:
    s_mov_b64 s[8:9], 0
    s_atomic_add_x2 s[8:9], s[32:33], s74 glc
    s_waitcnt vmcnt(5)
    ds_read_b128 v[116:119], v10 offset:47104
    ds_read_b128 v[124:127], v11 offset:47104
    s_add_u32 m0, s68, 45056
    s_nop 0
    buffer_load_dwordx4 v8, s[36:39], s69 offen offset:0 lds
    buffer_load_dwordx4 v9, s[36:39], s69 offen offset:1024 lds
    s_waitcnt vmcnt(4)
    ds_read_b128 v[128:131], v10 offset:40960
    ds_read_b128 v[136:139], v11 offset:40960
    s_waitcnt lgkmcnt(2)
    s_barrier
    s_cmp_ge_u32 s51, 5
    s_cbranch_scc1 L_rp12
    s_mov_b64 s[12:13], 1
    s_atomic_add_x2 s[12:13], s[32:33], s25 glc
L_rp12:
    s_add_u32 m0, s68, 47104
    s_add_u32 s64, s69, 20480
    s_add_u32 s69, s69, 128
    s_sub_u32 s66, s69, 1280
    s_min_u32 s69, s69, s66
    buffer_load_dwordx4 v8, s[36:39], s64 offen offset:0 lds
    buffer_load_dwordx4 v9, s[36:39], s64 offen offset:1024 lds
    s_waitcnt vmcnt(4)
    ds_read_b128 v[132:135], v10 offset:43008
    ds_read_b128 v[140:143], v11 offset:43008
    s_waitcnt lgkmcnt(2)
    s_add_u32 m0, s68, 40960
    s_nop 0
    buffer_load_dwordx4 v8, s[36:39], s69 offen offset:0 lds
    buffer_load_dwordx4 v9, s[36:39], s69 offen offset:1024 lds
    s_waitcnt vmcnt(4)
    ds_read_b128 v[144:147], v10 offset:45056
    ds_read_b128 v[152:155], v11 offset:45056
    s_waitcnt lgkmcnt(2)
    s_add_u32 m0, s68, 43008
    s_add_u32 s64, s69, 20480
    s_add_u32 s69, s69, 128
    s_sub_u32 s66, s69, 1280
    s_min_u32 s69, s69, s66
    buffer_load_dwordx4 v8, s[36:39], s64 offen offset:0 lds
    buffer_load_dwordx4 v9, s[36:39], s64 offen offset:1024 lds
    s_cmp_ge_u32 s3, 2
    s_cbranch_scc1 L_rp13
    s_sub_u32 s14, s8, s34
    s_subb_u32 s15, s9, s35
    s_xor_b32 s14, s14, 20
    s_or_b32 s14, s14, s15
    s_cbranch_scc0 L_as14
    s_waitcnt lgkmcnt(0)
    s_sub_u32 s8, s8, s34
    s_subb_u32 s9, s9, s35
    s_xor_b32 s8, s8, 20
    s_or_b32 s8, s8, s9
    s_cbranch_scc0 L_got15
    s_mov_b32 s72, 0
L_spin15:
    s_mov_b64 s[8:9], 0
    s_atomic_add_x2 s[8:9], s[32:33], s74 glc
    s_add_u32 s72, s72, 1
    s_cmp_ge_u32 s72, 131072
    s_waitcnt lgkmcnt(0)
    s_cbranch_scc1 L_got15
    s_sub_u32 s8, s8, s34
    s_subb_u32 s9, s9, s35
    s_xor_b32 s8, s8, 20
    s_or_b32 s8, s8, s9
    s_cbranch_scc1 L_spin15
L_got15:
L_as14:
    s_add_u32 s8, s34, 20
    s_addc_u32 s9, s35, 0
L_rp13:
    s_barrier
    s_mov_b64 s[14:15], s[8:9]
    s_sub_u32 s14, s14, s34
    s_subb_u32 s15, s15, s35
    s_xor_b32 s14, s14, 20
    s_or_b32 s14, s14, s15
    s_cbranch_scc1 L_slow16
L_back16:
    s_add_u32 m0, s67, 0
    s_nop 0
    buffer_load_dwordx4 v54, s[40:43], s70 offen sc1 lds
    s_add_u32 m0, s67, 4096
    s_add_u32 s70, s70, 4096
    s_sub_u32 s66, s70, 102400
    s_min_u32 s70, s70, s66
    buffer_load_dwordx4 v54, s[40:43], s70 offen sc1 lds
    s_add_u32 m0, s67, 8192
    s_add_u32 s70, s70, 4096
    s_sub_u32 s66, s70, 102400
    s_min_u32 s70, s70, s66
    buffer_load_dwordx4 v54, s[40:43], s70 offen sc1 lds
    s_add_u32 m0, s67, 12288
    s_add_u32 s70, s70, 4096
    s_sub_u32 s66, s70, 102400
    s_min_u32 s70, s70, s66
    buffer_load_dwordx4 v54, s[40:43], s70 offen sc1 lds
    s_add_u32 m0, s67, 16384
    s_add_u32 s70, s70, 4096
    s_sub_u32 s66, s70, 102400
    s_min_u32 s70, s70, s66
    buffer_load_dwordx4 v54, s[40:43], s70 offen sc1 lds
    s_add_u32 m0, s67, 20480
    s_add_u32 s70, s70, 4096
    s_sub_u32 s66, s70, 102400
    s_min_u32 s70, s70, s66
    buffer_load_dwordx4 v54, s[40:43], s70 offen sc1 lds
    s_add_u32 m0, s67, 24576
    s_add_u32 s70, s70, 4096
    s_sub_u32 s66, s70, 102400
    s_min_u32 s70, s70, s66
    buffer_load_dwordx4 v54, s[40:43], s70 offen sc1 lds
    s_add_u32 m0, s67, 28672
    s_add_u32 s70, s70, 4096
    s_sub_u32 s66, s70, 102400
    s_min_u32 s70, s70, s66
    buffer_load_dwordx4 v54, s[40:43], s70 offen sc1 lds
    s_add_u32 m0, s67, 32768
    s_add_u32 s70, s70, 4096
    s_sub_u32 s66, s70, 102400
    s_min_u32 s70, s70, s66
    buffer_load_dwordx4 v54, s[40:43], s70 offen sc1 lds
    s_add_u32 m0, s67, 36864
    s_add_u32 s70, s70, 4096
    s_sub_u32 s66, s70, 102400
    s_min_u32 s70, s70, s66
    buffer_load_dwordx4 v54, s[40:43], s70 offen sc1 lds
    s_waitcnt vmcnt(7)
    s_barrier
    ds_read_b128 v[36:39], v54 offset:0
    ds_read_b128 v[40:43], v54 offset:1024
    ds_read_b128 v[16:19], v54 offset:2048
    ds_read_b128 v[20:23], v54 offset:3072
    ds_read_b128 v[24:27], v54 offset:4096
    s_waitcnt lgkmcnt(4)
    v_mfma_f32_16x16x32_bf16 v[56:59], v[36:39], v[96:99], 0
    ds_read_b128 v[28:31], v54 offset:5120
    s_add_u32 m0, s68, 45056
    v_mfma_f32_16x16x32_bf16 v[60:63], v[36:39], v[100:103], 0
    buffer_load_dwordx4 v8, s[36:39], s69 offen offset:0 lds
    s_waitcnt lgkmcnt(4)
    v_mfma_f32_16x16x32_bf16 v[68:71], v[40:43], v[100:103], 0
    ds_read_b128 v[32:35], v54 offset:6144
    buffer_load_dwordx4 v9, s[36:39], s69 offen offset:1024 lds
    v_mfma_f32_16x16x32_bf16 v[64:67], v[40:43], v[96:99], 0
    ds_read_b128 v[148:151], v10 offset:47104
    ds_read_b128 v[156:159], v11 offset:47104
    s_waitcnt lgkmcnt(6)
    v_mfma_f32_16x16x32_bf16 v[72:75], v[16:19], v[96:99], 0
    ds_read_b128 v[36:39], v54 offset:7168
    v_mfma_f32_16x16x32_bf16 v[76:79], v[16:19], v[100:103], 0
    s_waitcnt lgkmcnt(6)
    v_mfma_f32_16x16x32_bf16 v[84:87], v[20:23], v[100:103], 0
    ds_read_b128 v[40:43], v54 offset:8192
    v_mfma_f32_16x16x32_bf16 v[80:83], v[20:23], v[96:99], 0
    s_waitcnt lgkmcnt(6)
    v_mfma_f32_16x16x32_bf16 v[88:91], v[24:27], v[96:99], 0
    ds_read_b128 v[16:19], v54 offset:9216
    v_mfma_f32_16x16x32_bf16 v[92:95], v[24:27], v[100:103], 0
    s_waitcnt vmcnt(7)
    s_barrier
    s_waitcnt lgkmcnt(6)
    v_mfma_f32_16x16x32_bf16 v[56:59], v[28:31], v[104:107], v[56:59]
    ds_read_b128 v[20:23], v54 offset:10240
    v_mfma_f32_16x16x32_bf16 v[60:63], v[28:31], v[108:111], v[60:63]
    s_waitcnt lgkmcnt(6)
    v_mfma_f32_16x16x32_bf16 v[68:71], v[32:35], v[108:111], v[68:71]
    ds_read_b128 v[24:27], v54 offset:11264
    ds_read_b128 v[160:163], v10 offset:40960
    ds_read_b128 v[168:171], v11 offset:40960
    v_mfma_f32_16x16x32_bf16 v[64:67], v[32:35], v[104:107], v[64:67]
    s_waitcnt lgkmcnt(6)
    v_mfma_f32_16x16x32_bf16 v[72:75], v[36:39], v[104:107], v[72:75]
    ds_read_b128 v[28:31], v54 offset:12288
    s_add_u32 m0, s68, 47104
    v_mfma_f32_16x16x32_bf16 v[76:79], v[36:39], v[108:111], v[76:79]
    s_add_u32 s64, s69, 20480
    s_waitcnt lgkmcnt(6)
    s_nop 0
    v_mfma_f32_16x16x32_bf16 v[84:87], v[40:43], v[108:111], v[84:87]
    ds_read_b128 v[32:35], v54 offset:13312
    s_add_u32 s69, s69, 128
    v_mfma_f32_16x16x32_bf16 v[80:83], v[40:43], v[104:107], v[80:83]
    s_sub_u32 s66, s69, 1280
    s_waitcnt lgkmcnt(6)
    v_mfma_f32_16x16x32_bf16 v[88:91], v[16:19], v[104:107], v[88:91]
    ds_read_b128 v[36:39], v54 offset:14336
    s_min_u32 s69, s69, s66
    v_mfma_f32_16x16x32_bf16 v[92:95], v[16:19], v[108:111], v[92:95]
    buffer_load_dwordx4 v8, s[36:39], s64 offen offset:0 lds
    s_waitcnt lgkmcnt(6)
    v_mfma_f32_16x16x32_bf16 v[56:59], v[20:23], v[112:115], v[56:59]
    ds_read_b128 v[40:43], v54 offset:15360
    buffer_load_dwordx4 v9, s[36:39], s64 offen offset:1024 lds
    v_mfma_f32_16x16x32_bf16 v[60:63], v[20:23], v[116:119], v[60:63]
    s_waitcnt lgkmcnt(6)
    v_mfma_f32_16x16x32_bf16 v[68:71], v[24:27], v[116:119], v[68:71]
    ds_read_b128 v[16:19], v54 offset:16384
    ds_read_b128 v[164:167], v10 offset:43008
    ds_read_b128 v[172:175], v11 offset:43008
    v_mfma_f32_16x16x32_bf16 v[64:67], v[24:27], v[112:115], v[64:67]
    s_waitcnt lgkmcnt(6)
    v_mfma_f32_16x16x32_bf16 v[72:75], v[28:31], v[112:115], v[72:75]
    ds_read_b128 v[20:23], v54 offset:17408
    s_add_u32 m0, s68, 40960
    v_mfma_f32_16x16x32_bf16 v[76:79], v[28:31], v[116:119], v[76:79]
    buffer_load_dwordx4 v8, s[36:39], s69 offen offset:0 lds
    s_waitcnt lgkmcnt(6)
    v_mfma_f32_16x16x32_bf16 v[84:87], v[32:35], v[116:119], v[84:87]
    ds_read_b128 v[24:27], v54 offset:18432
    buffer_load_dwordx4 v9, s[36:39], s69 offen offset:1024 lds
    v_mfma_f32_16x16x32_bf16 v[80:83], v[32:35], v[112:115], v[80:83]
    s_waitcnt lgkmcnt(6)
    v_mfma_f32_16x16x32_bf16 v[88:91], v[36:39], v[112:115], v[88:91]
    ds_read_b128 v[28:31], v54 offset:19456
    v_mfma_f32_16x16x32_bf16 v[92:95], v[36:39], v[116:119], v[92:95]
    s_waitcnt vmcnt(8)
    s_barrier
    s_waitcnt lgkmcnt(6)
    v_mfma_f32_16x16x32_bf16 v[56:59], v[40:43], v[120:123], v[56:59]
    ds_read_b128 v[32:35], v54 offset:20480
    s_add_u32 m0, s67, 0
    v_mfma_f32_16x16x32_bf16 v[60:63], v[40:43], v[124:127], v[60:63]
    s_add_u32 s70, s70, 4096
    s_waitcnt lgkmcnt(6)
    v_mfma_f32_16x16x32_bf16 v[68:71], v[16:19], v[124:127], v[68:71]
    ds_read_b128 v[36:39], v54 offset:21504
    s_sub_u32 s66, s70, 102400
    v_mfma_f32_16x16x32_bf16 v[64:67], v[16:19], v[120:123], v[64:67]
    s_min_u32 s70, s70, s66
    s_waitcnt lgkmcnt(4)
    v_mfma_f32_16x16x32_bf16 v[72:75], v[20:23], v[120:123], v[72:75]
    ds_read_b128 v[40:43], v54 offset:22528
    buffer_load_dwordx4 v54, s[40:43], s70 offen sc1 lds
    v_mfma_f32_16x16x32_bf16 v[76:79], v[20:23], v[124:127], v[76:79]
    s_add_u32 m0, s67, 4096
    s_waitcnt lgkmcnt(4)
    s_nop 0
    v_mfma_f32_16x16x32_bf16 v[84:87], v[24:27], v[124:127], v[84:87]
    ds_read_b128 v[16:19], v54 offset:23552
    s_add_u32 s70, s70, 4096
    v_mfma_f32_16x16x32_bf16 v[80:83], v[24:27], v[120:123], v[80:83]
    s_sub_u32 s66, s70, 102400
    s_waitcnt lgkmcnt(4)
    v_mfma_f32_16x16x32_bf16 v[88:91], v[28:31], v[120:123], v[88:91]
    ds_read_b128 v[20:23], v54 offset:24576
    s_min_u32 s70, s70, s66
    v_mfma_f32_16x16x32_bf16 v[92:95], v[28:31], v[124:127], v[92:95]
    buffer_load_dwordx4 v54, s[40:43], s70 offen sc1 lds
    s_waitcnt lgkmcnt(4)
    v_mfma_f32_16x16x32_bf16 v[56:59], v[32:35], v[128:131], v[56:59]
    ds_read_b128 v[24:27], v54 offset:25600
    s_waitcnt vmcnt(6)
    ds_read_b128 v[176:179], v10 offset:45056
    ds_read_b128 v[184:187], v11 offset:45056
    v_mfma_f32_16x16x32_bf16 v[60:63], v[32:35], v[132:135], v[60:63]
    s_add_u32 m0, s68, 43008
    s_waitcnt lgkmcnt(6)
    v_mfma_f32_16x16x32_bf16 v[68:71], v[36:39], v[132:135], v[68:71]
    ds_read_b128 v[28:31], v54 offset:26624
    s_add_u32 s64, s69, 20480
    v_mfma_f32_16x16x32_bf16 v[64:67], v[36:39], v[128:131], v[64:67]
    s_add_u32 s69, s69, 128
    s_waitcnt lgkmcnt(6)
    v_mfma_f32_16x16x32_bf16 v[72:75], v[40:43], v[128:131], v[72:75]
    ds_read_b128 v[32:35], v54 offset:27648
    s_sub_u32 s66, s69, 1280
    v_mfma_f32_16x16x32_bf16 v[76:79], v[40:43], v[132:135], v[76:79]
    s_min_u32 s69, s69, s66
    s_waitcnt lgkmcnt(6)
    v_mfma_f32_16x16x32_bf16 v[84:87], v[16:19], v[132:135], v[84:87]
    ds_read_b128 v[36:39], v54 offset:28672
    buffer_load_dwordx4 v8, s[36:39], s64 offen offset:0 lds
    v_mfma_f32_16x16x32_bf16 v[80:83], v[16:19], v[128:131], v[80:83]
    buffer_load_dwordx4 v9, s[36:39], s64 offen offset:1024 lds
    s_waitcnt lgkmcnt(6)
    v_mfma_f32_16x16x32_bf16 v[88:91], v[20:23], v[128:131], v[88:91]
    ds_read_b128 v[40:43], v54 offset:29696
    s_waitcnt vmcnt(6)
    ds_read_b128 v[180:183], v10 offset:47104
    ds_read_b128 v[188:191], v11 offset:47104
    v_mfma_f32_16x16x32_bf16 v[92:95], v[20:23], v[132:135], v[92:95]
    s_waitcnt lgkmcnt(6)
    s_add_u32 m0, s68, 45056
    s_nop 0
    buffer_load_dwordx4 v8, s[36:39], s69 offen offset:0 lds
    buffer_load_dwordx4 v9, s[36:39], s69 offen offset:1024 lds
    s_barrier
    v_mfma_f32_16x16x32_bf16 v[56:59], v[24:27], v[136:139], v[56:59]
    ds_read_b128 v[16:19], v54 offset:30720
    s_add_u32 m0, s67, 8192
    v_mfma_f32_16x16x32_bf16 v[60:63], v[24:27], v[140:143], v[60:63]
    s_add_u32 s70, s70, 4096
    s_waitcnt lgkmcnt(6)
    v_mfma_f32_16x16x32_bf16 v[68:71], v[28:31], v[140:143], v[68:71]
    ds_read_b128 v[20:23], v54 offset:31744
    s_sub_u32 s66, s70, 102400
    v_mfma_f32_16x16x32_bf16 v[64:67], v[28:31], v[136:139], v[64:67]
    s_min_u32 s70, s70, s66
    s_waitcnt lgkmcnt(6)
    v_mfma_f32_16x16x32_bf16 v[72:75], v[32:35], v[136:139], v[72:75]
    ds_read_b128 v[24:27], v54 offset:32768
    buffer_load_dwordx4 v54, s[40:43], s70 offen sc1 lds
    v_mfma_f32_16x16x32_bf16 v[76:79], v[32:35], v[140:143], v[76:79]
    s_add_u32 m0, s67, 12288
    s_waitcnt lgkmcnt(6)
    v_mfma_f32_16x16x32_bf16 v[84:87], v[36:39], v[140:143], v[84:87]
    ds_read_b128 v[28:31], v54 offset:33792
    s_add_u32 s70, s70, 4096
    v_mfma_f32_16x16x32_bf16 v[80:83], v[36:39], v[136:139], v[80:83]
    s_sub_u32 s66, s70, 102400
    s_waitcnt lgkmcnt(6)
    v_mfma_f32_16x16x32_bf16 v[88:91], v[40:43], v[136:139], v[88:91]
    ds_read_b128 v[32:35], v54 offset:34816
    s_min_u32 s70, s70, s66
    v_mfma_f32_16x16x32_bf16 v[92:95], v[40:43], v[140:143], v[92:95]
    buffer_load_dwordx4 v54, s[40:43], s70 offen sc1 lds
    s_waitcnt lgkmcnt(4)
    v_mfma_f32_16x16x32_bf16 v[56:59], v[16:19], v[144:147], v[56:59]
    ds_read_b128 v[36:39], v54 offset:35840
    s_add_u32 m0, s67, 16384
    v_mfma_f32_16x16x32_bf16 v[60:63], v[16:19], v[148:151], v[60:63]
    s_add_u32 s70, s70, 4096
    s_waitcnt lgkmcnt(4)
    s_nop 0
    v_mfma_f32_16x16x32_bf16 v[68:71], v[20:23], v[148:151], v[68:71]
    ds_read_b128 v[40:43], v54 offset:36864
    s_sub_u32 s66, s70, 102400
    v_mfma_f32_16x16x32_bf16 v[64:67], v[20:23], v[144:147], v[64:67]
    s_min_u32 s70, s70, s66
    s_waitcnt lgkmcnt(4)
    v_mfma_f32_16x16x32_bf16 v[72:75], v[24:27], v[144:147], v[72:75]
    ds_read_b128 v[16:19], v54 offset:37888
    buffer_load_dwordx4 v54, s[40:43], s70 offen sc1 lds
    v_mfma_f32_16x16x32_bf16 v[76:79], v[24:27], v[148:151], v[76:79]
    s_waitcnt vmcnt(9)
    ds_read_b128 v[192:195], v10 offset:40960
    ds_read_b128 v[200:203], v11 offset:40960
    s_waitcnt lgkmcnt(6)
    v_mfma_f32_16x16x32_bf16 v[84:87], v[28:31], v[148:151], v[84:87]
    ds_read_b128 v[20:23], v54 offset:38912
    s_add_u32 m0, s68, 47104
    v_mfma_f32_16x16x32_bf16 v[80:83], v[28:31], v[144:147], v[80:83]
    s_add_u32 s64, s69, 20480
    s_waitcnt lgkmcnt(6)
    s_nop 0
    v_mfma_f32_16x16x32_bf16 v[88:91], v[32:35], v[144:147], v[88:91]
    ds_read_b128 v[24:27], v54 offset:39936
    s_add_u32 s69, s69, 128
    v_mfma_f32_16x16x32_bf16 v[92:95], v[32:35], v[148:151], v[92:95]
    s_sub_u32 s66, s69, 1280
    s_min_u32 s69, s69, s66
    buffer_load_dwordx4 v8, s[36:39], s64 offen offset:0 lds
    buffer_load_dwordx4 v9, s[36:39], s64 offen offset:1024 lds
    s_waitcnt vmcnt(7)
    ds_read_b128 v[196:199], v10 offset:43008
    ds_read_b128 v[204:207], v11 offset:43008
    s_waitcnt lgkmcnt(4)
    s_add_u32 m0, s68, 40960
    s_nop 0
    buffer_load_dwordx4 v8, s[36:39], s69 offen offset:0 lds
    buffer_load_dwordx4 v9, s[36:39], s69 offen offset:1024 lds
    s_waitcnt vmcnt(6)
    s_barrier
    v_mfma_f32_16x16x32_bf16 v[56:59], v[36:39], v[152:155], v[56:59]
    ds_read_b128 v[28:31], v54 offset:0
    s_add_u32 m0, s67, 20480
    v_mfma_f32_16x16x32_bf16 v[60:63], v[36:39], v[156:159], v[60:63]
    s_add_u32 s70, s70, 4096
    v_mfma_f32_16x16x32_bf16 v[68:71], v[40:43], v[156:159], v[68:71]
    ds_read_b128 v[32:35], v54 offset:1024
    s_sub_u32 s66, s70, 102400
    v_mfma_f32_16x16x32_bf16 v[64:67], v[40:43], v[152:155], v[64:67]
    s_min_u32 s70, s70, s66
    v_mfma_f32_16x16x32_bf16 v[72:75], v[16:19], v[152:155], v[72:75]
    ds_read_b128 v[36:39], v54 offset:2048
    buffer_load_dwordx4 v54, s[40:43], s70 offen sc1 lds
    v_mfma_f32_16x16x32_bf16 v[76:79], v[16:19], v[156:159], v[76:79]
    s_add_u32 m0, s67, 24576
    s_waitcnt lgkmcnt(6)
    v_mfma_f32_16x16x32_bf16 v[84:87], v[20:23], v[156:159], v[84:87]
    ds_read_b128 v[40:43], v54 offset:3072
    s_add_u32 s70, s70, 4096
    v_mfma_f32_16x16x32_bf16 v[80:83], v[20:23], v[152:155], v[80:83]
    s_sub_u32 s66, s70, 102400
    s_waitcnt lgkmcnt(6)
    v_mfma_f32_16x16x32_bf16 v[88:91], v[24:27], v[152:155], v[88:91]
    ds_read_b128 v[16:19], v54 offset:4096
    s_min_u32 s70, s70, s66
    v_mfma_f32_16x16x32_bf16 v[92:95], v[24:27], v[156:159], v[92:95]
    buffer_load_dwordx4 v54, s[40:43], s70 offen sc1 lds
    s_waitcnt lgkmcnt(4)
    s_nop 0
    v_mfma_f32_16x16x32_bf16 v[56:59], v[28:31], v[160:163], v[56:59]
    ds_read_b128 v[20:23], v54 offset:5120
    ds_read_b128 v[208:211], v10 offset:45056
    ds_read_b128 v[216:219], v11 offset:45056
    v_mfma_f32_16x16x32_bf16 v[60:63], v[28:31], v[164:167], v[60:63]
    s_add_u32 m0, s68, 43008
    s_waitcnt lgkmcnt(6)
    v_mfma_f32_16x16x32_bf16 v[68:71], v[32:35], v[164:167], v[68:71]
    ds_read_b128 v[24:27], v54 offset:6144
    s_add_u32 s64, s69, 20480
    v_mfma_f32_16x16x32_bf16 v[64:67], v[32:35], v[160:163], v[64:67]
    s_add_u32 s69, s69, 128
    s_waitcnt lgkmcnt(6)
    v_mfma_f32_16x16x32_bf16 v[72:75], v[36:39], v[160:163], v[72:75]
    ds_read_b128 v[28:31], v54 offset:7168
    s_sub_u32 s66, s69, 1280
    v_mfma_f32_16x16x32_bf16 v[76:79], v[36:39], v[164:167], v[76:79]
    s_min_u32 s69, s69, s66
    s_waitcnt lgkmcnt(6)
    v_mfma_f32_16x16x32_bf16 v[84:87], v[40:43], v[164:167], v[84:87]
    ds_read_b128 v[32:35], v54 offset:8192
    buffer_load_dwordx4 v8, s[36:39], s64 offen offset:0 lds
    v_mfma_f32_16x16x32_bf16 v[80:83], v[40:43], v[160:163], v[80:83]
    buffer_load_dwordx4 v9, s[36:39], s64 offen offset:1024 lds
    s_waitcnt lgkmcnt(6)
    v_mfma_f32_16x16x32_bf16 v[88:91], v[16:19], v[160:163], v[88:91]
    ds_read_b128 v[36:39], v54 offset:9216
    s_waitcnt vmcnt(6)
    ds_read_b128 v[212:215], v10 offset:47104
    ds_read_b128 v[220:223], v11 offset:47104
    v_mfma_f32_16x16x32_bf16 v[92:95], v[16:19], v[164:167], v[92:95]
    s_waitcnt lgkmcnt(6)
    s_add_u32 m0, s68, 45056
    s_nop 0
    buffer_load_dwordx4 v8, s[36:39], s69 offen offset:0 lds
    buffer_load_dwordx4 v9, s[36:39], s69 offen offset:1024 lds
    s_barrier
    v_mfma_f32_16x16x32_bf16 v[56:59], v[20:23], v[168:171], v[56:59]
    ds_read_b128 v[40:43], v54 offset:10240
    s_add_u32 m0, s67, 28672
    v_mfma_f32_16x16x32_bf16 v[60:63], v[20:23], v[172:175], v[60:63]
    s_add_u32 s70, s70, 4096
    s_waitcnt lgkmcnt(6)
    v_mfma_f32_16x16x32_bf16 v[68:71], v[24:27], v[172:175], v[68:71]
    ds_read_b128 v[16:19], v54 offset:11264
    s_sub_u32 s66, s70, 102400
    v_mfma_f32_16x16x32_bf16 v[64:67], v[24:27], v[168:171], v[64:67]
    s_min_u32 s70, s70, s66
    s_waitcnt lgkmcnt(6)
    v_mfma_f32_16x16x32_bf16 v[72:75], v[28:31], v[168:171], v[72:75]
    ds_read_b128 v[20:23], v54 offset:12288
    buffer_load_dwordx4 v54, s[40:43], s70 offen sc1 lds
    v_mfma_f32_16x16x32_bf16 v[76:79], v[28:31], v[172:175], v[76:79]
    s_add_u32 m0, s67, 32768
    s_waitcnt lgkmcnt(6)
    v_mfma_f32_16x16x32_bf16 v[84:87], v[32:35], v[172:175], v[84:87]
    ds_read_b128 v[24:27], v54 offset:13312
    s_add_u32 s70, s70, 4096
    v_mfma_f32_16x16x32_bf16 v[80:83], v[32:35], v[168:171], v[80:83]
    s_sub_u32 s66, s70, 102400
    s_waitcnt lgkmcnt(6)
L_pageB0:
    s_cbranch_execz L_warmB
    s_nop 0
    v_mfma_f32_16x16x32_bf16 v[88:91], v[36:39], v[168:171], v[88:91]
    ds_read_b128 v[28:31], v54 offset:14336
    s_min_u32 s70, s70, s66
    v_mfma_f32_16x16x32_bf16 v[92:95], v[36:39], v[172:175], v[92:95]
    buffer_load_dwordx4 v54, s[40:43], s70 offen sc1 lds
    s_waitcnt lgkmcnt(4)
    v_mfma_f32_16x16x32_bf16 v[56:59], v[40:43], v[176:179], v[56:59]
    ds_read_b128 v[32:35], v54 offset:15360
    s_add_u32 m0, s67, 36864
    v_mfma_f32_16x16x32_bf16 v[60:63], v[40:43], v[180:183], v[60:63]
    s_add_u32 s70, s70, 4096
    s_waitcnt lgkmcnt(4)
    s_nop 0
    v_mfma_f32_16x16x32_bf16 v[68:71], v[16:19], v[180:183], v[68:71]
    ds_read_b128 v[36:39], v54 offset:16384
    s_sub_u32 s66, s70, 102400
    v_mfma_f32_16x16x32_bf16 v[64:67], v[16:19], v[176:179], v[64:67]
    s_min_u32 s70, s70, s66
    s_waitcnt lgkmcnt(4)
    v_mfma_f32_16x16x32_bf16 v[72:75], v[20:23], v[176:179], v[72:75]
    ds_read_b128 v[40:43], v54 offset:17408
    buffer_load_dwordx4 v54, s[40:43], s70 offen sc1 lds
    v_mfma_f32_16x16x32_bf16 v[76:79], v[20:23], v[180:183], v[76:79]
    s_waitcnt vmcnt(9)
    ds_read_b128 v[224:227], v10 offset:40960
    ds_read_b128 v[232:235], v11 offset:40960
    s_waitcnt lgkmcnt(6)
    v_mfma_f32_16x16x32_bf16 v[84:87], v[24:27], v[180:183], v[84:87]
    ds_read_b128 v[16:19], v54 offset:18432
    s_add_u32 m0, s68, 47104
    v_mfma_f32_16x16x32_bf16 v[80:83], v[24:27], v[176:179], v[80:83]
    s_add_u32 s64, s69, 20480
    s_waitcnt lgkmcnt(6)
    s_nop 0
    v_mfma_f32_16x16x32_bf16 v[88:91], v[28:31], v[176:179], v[88:91]
    ds_read_b128 v[20:23], v54 offset:19456
    s_add_u32 s69, s69, 128
    v_mfma_f32_16x16x32_bf16 v[92:95], v[28:31], v[180:183], v[92:95]
    s_sub_u32 s66, s69, 1280
    s_min_u32 s69, s69, s66
    buffer_load_dwordx4 v8, s[36:39], s64 offen offset:0 lds
    buffer_load_dwordx4 v9, s[36:39], s64 offen offset:1024 lds
    s_waitcnt vmcnt(7)
    ds_read_b128 v[228:231], v10 offset:43008
    ds_read_b128 v[236:239], v11 offset:43008
    s_waitcnt lgkmcnt(4)
    s_waitcnt vmcnt(4)
    s_barrier
    v_mfma_f32_16x16x32_bf16 v[56:59], v[32:35], v[184:187], v[56:59]
    ds_read_b128 v[24:27], v54 offset:20480
    s_add_u32 m0, s67, 0
    v_mfma_f32_16x16x32_bf16 v[60:63], v[32:35], v[188:191], v[60:63]
    s_add_u32 s70, s70, 4096
    v_mfma_f32_16x16x32_bf16 v[68:71], v[36:39], v[188:191], v[68:71]
    ds_read_b128 v[28:31], v54 offset:21504
    s_sub_u32 s66, s70, 102400
    v_mfma_f32_16x16x32_bf16 v[64:67], v[36:39], v[184:187], v[64:67]
    s_min_u32 s70, s70, s66
    v_mfma_f32_16x16x32_bf16 v[72:75], v[40:43], v[184:187], v[72:75]
    ds_read_b128 v[32:35], v54 offset:22528
    buffer_load_dwordx4 v54, s[40:43], s70 offen sc1 lds
    v_mfma_f32_16x16x32_bf16 v[76:79], v[40:43], v[188:191], v[76:79]
    s_add_u32 m0, s67, 4096
    s_waitcnt lgkmcnt(6)
    v_mfma_f32_16x16x32_bf16 v[84:87], v[16:19], v[188:191], v[84:87]
    ds_read_b128 v[36:39], v54 offset:23552
    s_add_u32 s70, s70, 4096
    v_mfma_f32_16x16x32_bf16 v[80:83], v[16:19], v[184:187], v[80:83]
    s_sub_u32 s66, s70, 102400
    s_waitcnt lgkmcnt(6)
    v_mfma_f32_16x16x32_bf16 v[88:91], v[20:23], v[184:187], v[88:91]
    ds_read_b128 v[40:43], v54 offset:24576
    s_min_u32 s70, s70, s66
    v_mfma_f32_16x16x32_bf16 v[92:95], v[20:23], v[188:191], v[92:95]
    buffer_load_dwordx4 v54, s[40:43], s70 offen sc1 lds
    s_waitcnt lgkmcnt(4)
    s_nop 0
    v_mfma_f32_16x16x32_bf16 v[56:59], v[24:27], v[192:195], v[56:59]
    ds_read_b128 v[16:19], v54 offset:25600
    ds_read_b128 v[240:243], v10 offset:45056
    ds_read_b128 v[248:251], v11 offset:45056
    v_mfma_f32_16x16x32_bf16 v[60:63], v[24:27], v[196:199], v[60:63]
    s_waitcnt lgkmcnt(6)
    v_mfma_f32_16x16x32_bf16 v[68:71], v[28:31], v[196:199], v[68:71]
    ds_read_b128 v[20:23], v54 offset:26624
    s_waitcnt vmcnt(2)
    ds_read_b128 v[244:247], v10 offset:47104
    ds_read_b128 v[252:255], v11 offset:47104
    v_mfma_f32_16x16x32_bf16 v[64:67], v[28:31], v[192:195], v[64:67]
    s_waitcnt lgkmcnt(8)
    v_mfma_f32_16x16x32_bf16 v[72:75], v[32:35], v[192:195], v[72:75]
    ds_read_b128 v[24:27], v54 offset:27648
    s_waitcnt lgkmcnt(4)
    v_mfma_f32_16x16x32_bf16 v[76:79], v[32:35], v[196:199], v[76:79]
    v_mfma_f32_16x16x32_bf16 v[84:87], v[36:39], v[196:199], v[84:87]
    ds_read_b128 v[28:31], v54 offset:28672
    v_mfma_f32_16x16x32_bf16 v[80:83], v[36:39], v[192:195], v[80:83]
    v_mfma_f32_16x16x32_bf16 v[88:91], v[40:43], v[192:195], v[88:91]
    ds_read_b128 v[32:35], v54 offset:29696
    v_mfma_f32_16x16x32_bf16 v[92:95], v[40:43], v[196:199], v[92:95]
    s_barrier
    v_mfma_f32_16x16x32_bf16 v[56:59], v[16:19], v[200:203], v[56:59]
    ds_read_b128 v[36:39], v54 offset:30720
    s_add_u32 m0, s67, 8192
    v_mfma_f32_16x16x32_bf16 v[60:63], v[16:19], v[204:207], v[60:63]
    s_add_u32 s70, s70, 4096
    s_waitcnt lgkmcnt(6)
    v_mfma_f32_16x16x32_bf16 v[68:71], v[20:23], v[204:207], v[68:71]
    ds_read_b128 v[40:43], v54 offset:31744
    s_sub_u32 s66, s70, 102400
    v_mfma_f32_16x16x32_bf16 v[64:67], v[20:23], v[200:203], v[64:67]
    s_min_u32 s70, s70, s66
    s_waitcnt lgkmcnt(4)
    v_mfma_f32_16x16x32_bf16 v[72:75], v[24:27], v[200:203], v[72:75]
    ds_read_b128 v[16:19], v54 offset:32768
    buffer_load_dwordx4 v54, s[40:43], s70 offen sc1 lds
    v_mfma_f32_16x16x32_bf16 v[76:79], v[24:27], v[204:207], v[76:79]
    s_add_u32 m0, s67, 12288
    s_waitcnt lgkmcnt(4)
    v_mfma_f32_16x16x32_bf16 v[84:87], v[28:31], v[204:207], v[84:87]
    ds_read_b128 v[20:23], v54 offset:33792
    s_add_u32 s70, s70, 4096
    v_mfma_f32_16x16x32_bf16 v[80:83], v[28:31], v[200:203], v[80:83]
    s_sub_u32 s66, s70, 102400
    s_waitcnt lgkmcnt(4)
    v_mfma_f32_16x16x32_bf16 v[88:91], v[32:35], v[200:203], v[88:91]
    ds_read_b128 v[24:27], v54 offset:34816
    s_min_u32 s70, s70, s66
    v_mfma_f32_16x16x32_bf16 v[92:95], v[32:35], v[204:207], v[92:95]
    buffer_load_dwordx4 v54, s[40:43], s70 offen sc1 lds
    s_waitcnt lgkmcnt(4)
    v_mfma_f32_16x16x32_bf16 v[56:59], v[36:39], v[208:211], v[56:59]
    ds_read_b128 v[28:31], v54 offset:35840
    s_add_u32 m0, s67, 16384
    v_mfma_f32_16x16x32_bf16 v[60:63], v[36:39], v[212:215], v[60:63]
    s_add_u32 s70, s70, 4096
    s_waitcnt lgkmcnt(4)
    s_nop 0
    v_mfma_f32_16x16x32_bf16 v[68:71], v[40:43], v[212:215], v[68:71]
    ds_read_b128 v[32:35], v54 offset:36864
    s_sub_u32 s66, s70, 102400
    v_mfma_f32_16x16x32_bf16 v[64:67], v[40:43], v[208:211], v[64:67]
    s_min_u32 s70, s70, s66
    s_waitcnt lgkmcnt(4)
    v_mfma_f32_16x16x32_bf16 v[72:75], v[16:19], v[208:211], v[72:75]
    ds_read_b128 v[36:39], v54 offset:37888
    buffer_load_dwordx4 v54, s[40:43], s70 offen sc1 lds
    v_mfma_f32_16x16x32_bf16 v[76:79], v[16:19], v[212:215], v[76:79]
    s_sub_u32 s14, s8, s34
    s_subb_u32 s15, s9, s35
    s_xor_b32 s14, s14, 20
    s_or_b32 s14, s14, s15
    s_cbranch_scc1 L_slow17
L_back17:
    s_waitcnt lgkmcnt(4)
    v_mfma_f32_16x16x32_bf16 v[84:87], v[20:23], v[212:215], v[84:87]
    ds_read_b128 v[40:43], v54 offset:38912
    v_mfma_f32_16x16x32_bf16 v[80:83], v[20:23], v[208:211], v[80:83]
    s_waitcnt lgkmcnt(4)
    v_mfma_f32_16x16x32_bf16 v[88:91], v[24:27], v[208:211], v[88:91]
    ds_read_b128 v[16:19], v54 offset:39936
    v_mfma_f32_16x16x32_bf16 v[92:95], v[24:27], v[212:215], v[92:95]
    s_waitcnt vmcnt(2)
    s_barrier
    s_waitcnt lgkmcnt(4)
    v_mfma_f32_16x16x32_bf16 v[56:59], v[28:31], v[216:219], v[56:59]
    ds_read_b128 v[20:23], v54 offset:0
    v_mfma_f32_16x16x32_bf16 v[60:63], v[28:31], v[220:223], v[60:63]
    s_add_u32 m0, s67, 40960
    s_waitcnt lgkmcnt(4)
    v_mfma_f32_16x16x32_bf16 v[68:71], v[32:35], v[220:223], v[68:71]
    ds_read_b128 v[24:27], v54 offset:1024
    buffer_load_dwordx4 v54, s[52:55], s71 offen sc1 lds
    v_mfma_f32_16x16x32_bf16 v[64:67], v[32:35], v[216:219], v[64:67]
    s_add_u32 m0, s67, 45056
    s_waitcnt lgkmcnt(4)
    v_mfma_f32_16x16x32_bf16 v[72:75], v[36:39], v[216:219], v[72:75]
    ds_read_b128 v[28:31], v54 offset:2048
    s_add_u32 s71, s71, 4096
    v_mfma_f32_16x16x32_bf16 v[76:79], v[36:39], v[220:223], v[76:79]
    s_sub_u32 s66, s71, 61440
    s_waitcnt lgkmcnt(4)
    v_mfma_f32_16x16x32_bf16 v[84:87], v[40:43], v[220:223], v[84:87]
    ds_read_b128 v[32:35], v54 offset:3072
    s_min_u32 s71, s71, s66
    v_mfma_f32_16x16x32_bf16 v[80:83], v[40:43], v[216:219], v[80:83]
    buffer_load_dwordx4 v54, s[52:55], s71 offen sc1 lds
    s_waitcnt lgkmcnt(4)
    v_mfma_f32_16x16x32_bf16 v[88:91], v[16:19], v[216:219], v[88:91]
    ds_read_b128 v[36:39], v54 offset:4096
    s_add_u32 m0, s67, 49152
    v_mfma_f32_16x16x32_bf16 v[92:95], v[16:19], v[220:223], v[92:95]
    s_add_u32 s71, s71, 4096
    s_waitcnt lgkmcnt(4)
    v_mfma_f32_16x16x32_bf16 v[56:59], v[20:23], v[224:227], v[56:59]
    ds_read_b128 v[40:43], v54 offset:5120
    s_sub_u32 s66, s71, 61440
    v_mfma_f32_16x16x32_bf16 v[60:63], v[20:23], v[228:231], v[60:63]
    s_min_u32 s71, s71, s66
    s_waitcnt lgkmcnt(4)
    v_mfma_f32_16x16x32_bf16 v[68:71], v[24:27], v[228:231], v[68:71]
    ds_read_b128 v[16:19], v54 offset:6144
    buffer_load_dwordx4 v54, s[52:55], s71 offen sc1 lds
    v_mfma_f32_16x16x32_bf16 v[64:67], v[24:27], v[224:227], v[64:67]
    s_waitcnt lgkmcnt(4)
    v_mfma_f32_16x16x32_bf16 v[72:75], v[28:31], v[224:227], v[72:75]
    ds_read_b128 v[20:23], v54 offset:7168
    v_mfma_f32_16x16x32_bf16 v[76:79], v[28:31], v[228:231], v[76:79]
    s_waitcnt lgkmcnt(4)
    v_mfma_f32_16x16x32_bf16 v[84:87], v[32:35], v[228:231], v[84:87]
    ds_read_b128 v[24:27], v54 offset:8192
    v_mfma_f32_16x16x32_bf16 v[80:83], v[32:35], v[224:227], v[80:83]
    s_waitcnt lgkmcnt(4)
    v_mfma_f32_16x16x32_bf16 v[88:91], v[36:39], v[224:227], v[88:91]
    ds_read_b128 v[28:31], v54 offset:9216
    v_mfma_f32_16x16x32_bf16 v[92:95], v[36:39], v[228:231], v[92:95]
    s_waitcnt vmcnt(3)
    s_barrier
    s_waitcnt lgkmcnt(4)
    v_mfma_f32_16x16x32_bf16 v[56:59], v[40:43], v[232:235], v[56:59]
    ds_read_b128 v[32:35], v54 offset:10240
    v_mfma_f32_16x16x32_bf16 v[60:63], v[40:43], v[236:239], v[60:63]
    s_add_u32 m0, s67, 53248
    s_waitcnt lgkmcnt(4)
    v_mfma_f32_16x16x32_bf16 v[68:71], v[16:19], v[236:239], v[68:71]
    ds_read_b128 v[36:39], v54 offset:11264
    s_add_u32 s71, s71, 4096
    v_mfma_f32_16x16x32_bf16 v[64:67], v[16:19], v[232:235], v[64:67]
    s_sub_u32 s66, s71, 61440
    s_waitcnt lgkmcnt(4)
    v_mfma_f32_16x16x32_bf16 v[72:75], v[20:23], v[232:235], v[72:75]
    ds_read_b128 v[40:43], v54 offset:12288
    s_min_u32 s71, s71, s66
    v_mfma_f32_16x16x32_bf16 v[76:79], v[20:23], v[236:239], v[76:79]
    buffer_load_dwordx4 v54, s[52:55], s71 offen sc1 lds
    s_waitcnt lgkmcnt(4)
    v_mfma_f32_16x16x32_bf16 v[84:87], v[24:27], v[236:239], v[84:87]
    ds_read_b128 v[16:19], v54 offset:13312
    s_add_u32 m0, s67, 57344
    v_mfma_f32_16x16x32_bf16 v[80:83], v[24:27], v[232:235], v[80:83]
    s_add_u32 s71, s71, 4096
    s_waitcnt lgkmcnt(4)
    s_nop 0
    v_mfma_f32_16x16x32_bf16 v[88:91], v[28:31], v[232:235], v[88:91]
    ds_read_b128 v[20:23], v54 offset:14336
    s_sub_u32 s66, s71, 61440
    v_mfma_f32_16x16x32_bf16 v[92:95], v[28:31], v[236:239], v[92:95]
    s_min_u32 s71, s71, s66
    s_waitcnt lgkmcnt(4)
    v_mfma_f32_16x16x32_bf16 v[56:59], v[32:35], v[240:243], v[56:59]
    ds_read_b128 v[24:27], v54 offset:15360
    buffer_load_dwordx4 v54, s[52:55], s71 offen sc1 lds
    v_mfma_f32_16x16x32_bf16 v[60:63], v[32:35], v[244:247], v[60:63]
    s_add_u32 m0, s67, 61440
    s_waitcnt lgkmcnt(4)
    s_nop 0
    v_mfma_f32_16x16x32_bf16 v[68:71], v[36:39], v[244:247], v[68:71]
    ds_read_b128 v[28:31], v54 offset:16384
    s_add_u32 s71, s71, 4096
    v_mfma_f32_16x16x32_bf16 v[64:67], v[36:39], v[240:243], v[64:67]
    s_sub_u32 s66, s71, 61440
    s_waitcnt lgkmcnt(4)
    v_mfma_f32_16x16x32_bf16 v[72:75], v[40:43], v[240:243], v[72:75]
    ds_read_b128 v[32:35], v54 offset:17408
    s_min_u32 s71, s71, s66
    v_mfma_f32_16x16x32_bf16 v[76:79], v[40:43], v[244:247], v[76:79]
    buffer_load_dwordx4 v54, s[52:55], s71 offen sc1 lds
    s_waitcnt lgkmcnt(4)
    v_mfma_f32_16x16x32_bf16 v[84:87], v[16:19], v[244:247], v[84:87]
    ds_read_b128 v[36:39], v54 offset:18432
    v_mfma_f32_16x16x32_bf16 v[80:83], v[16:19], v[240:243], v[80:83]
    s_waitcnt lgkmcnt(4)
    v_mfma_f32_16x16x32_bf16 v[88:91], v[20:23], v[240:243], v[88:91]
    ds_read_b128 v[40:43], v54 offset:19456
    v_mfma_f32_16x16x32_bf16 v[92:95], v[20:23], v[244:247], v[92:95]
    s_waitcnt lgkmcnt(4)
    v_mfma_f32_16x16x32_bf16 v[56:59], v[24:27], v[248:251], v[56:59]
    v_mfma_f32_16x16x32_bf16 v[60:63], v[24:27], v[252:255], v[60:63]
    s_add_u32 m0, s67, 65536
    s_waitcnt lgkmcnt(3)
    v_mfma_f32_16x16x32_bf16 v[68:71], v[28:31], v[252:255], v[68:71]
    s_add_u32 s71, s71, 4096
    s_sub_u32 s66, s71, 61440
    v_mfma_f32_16x16x32_bf16 v[64:67], v[28:31], v[248:251], v[64:67]
    s_min_u32 s71, s71, s66
    s_waitcnt lgkmcnt(2)
    v_mfma_f32_16x16x32_bf16 v[72:75], v[32:35], v[248:251], v[72:75]
    buffer_load_dwordx4 v54, s[52:55], s71 offen sc1 lds
    s_add_u32 m0, s67, 69632
    v_mfma_f32_16x16x32_bf16 v[76:79], v[32:35], v[252:255], v[76:79]
    s_add_u32 s71, s71, 4096
    s_waitcnt lgkmcnt(1)
    v_mfma_f32_16x16x32_bf16 v[84:87], v[36:39], v[252:255], v[84:87]
    s_sub_u32 s66, s71, 61440
    s_min_u32 s71, s71, s66
    v_mfma_f32_16x16x32_bf16 v[80:83], v[36:39], v[248:251], v[80:83]
    buffer_load_dwordx4 v54, s[52:55], s71 offen sc1 lds
    s_waitcnt lgkmcnt(0)
    v_mfma_f32_16x16x32_bf16 v[88:91], v[40:43], v[248:251], v[88:91]
    s_add_u32 m0, s67, 73728
    s_add_u32 s71, s71, 4096
    v_mfma_f32_16x16x32_bf16 v[92:95], v[40:43], v[252:255], v[92:95]
    s_sub_u32 s66, s71, 61440
    s_min_u32 s71, s71, s66
    buffer_load_dwordx4 v54, s[52:55], s71 offen sc1 lds
    v_mov_b32 v18, 0
    v_mov_b32 v19, 0
    v_cvt_pk_bf16_f32 v8, v56, v57
    v_cvt_pk_bf16_f32 v9, v58, v59
    v_cvt_pk_bf16_f32 v20, v60, v61
    v_cvt_pk_bf16_f32 v21, v62, v63
    v_cvt_pk_bf16_f32 v10, v64, v65
    v_cvt_pk_bf16_f32 v11, v66, v67
    v_cvt_pk_bf16_f32 v22, v68, v69
    v_cvt_pk_bf16_f32 v23, v70, v71
    ds_read_b64_tr_b16 v[56:57], v49 offset:0
    ds_read_b64_tr_b16 v[58:59], v49 offset:160
    ds_read_b64_tr_b16 v[60:61], v49 offset:320
    ds_read_b64_tr_b16 v[62:63], v49 offset:480
    ds_read_b64_tr_b16 v[64:65], v49 offset:640
    v_mov_b32 v66, 0
    v_mov_b32 v67, 0
    v_cvt_pk_bf16_f32 v12, v72, v73
    v_cvt_pk_bf16_f32 v13, v74, v75
    v_cvt_pk_bf16_f32 v24, v76, v77
    v_cvt_pk_bf16_f32 v25, v78, v79
    ds_read_b64_tr_b16 v[68:69], v50 offset:0
    ds_read_b64_tr_b16 v[70:71], v50 offset:160
    ds_read_b64_tr_b16 v[72:73], v50 offset:320
    ds_read_b64_tr_b16 v[74:75], v50 offset:480
    ds_read_b64_tr_b16 v[76:77], v50 offset:640
    v_mov_b32 v78, 0
    v_mov_b32 v79, 0
    v_cvt_pk_bf16_f32 v14, v80, v81
    v_cvt_pk_bf16_f32 v15, v82, v83
    v_cvt_pk_bf16_f32 v26, v84, v85
    v_cvt_pk_bf16_f32 v27, v86, v87
    v_cvt_pk_bf16_f32 v16, v88, v89
    v_cvt_pk_bf16_f32 v17, v90, v91
    v_cvt_pk_bf16_f32 v28, v92, v93
    v_cvt_pk_bf16_f32 v29, v94, v95
    v_permlane16_swap_b32 v8, v20
    v_permlane16_swap_b32 v9, v21
    v_permlane16_swap_b32 v10, v22
    v_permlane16_swap_b32 v11, v23
    s_waitcnt lgkmcnt(0)
    s_nop 0
    v_mfma_f32_16x16x32_bf16 v[32:35], v[68:71], v[8:11], 0
    v_mfma_f32_32x32x16_bf16 v[80:95], v[56:59], v[8:11], 0
    s_sub_u32 s12, s12, s34
    s_subb_u32 s13, s13, s35
    s_lshr_b32 s12, s12, 8
    s_or_b32 s12, s12, s13
    s_cbranch_scc1 L_slow19
L_back19:
    v_permlane16_swap_b32 v12, v24
    v_permlane16_swap_b32 v13, v25
    v_permlane16_swap_b32 v14, v26
    v_permlane16_swap_b32 v15, v27
    v_mov_b32 v30, 0x3f80
    v_mov_b32 v31, 0
    v_mfma_f32_16x16x32_bf16 v[32:35], v[72:75], v[12:15], v[32:35]
    v_mfma_f32_32x32x16_bf16 v[80:95], v[60:63], v[12:15], v[80:95]
    v_permlane16_swap_b32 v16, v28
    v_permlane16_swap_b32 v17, v29
    s_nop 1
    v_mfma_f32_16x16x32_bf16 v[32:35], v[76:79], v[16:19], v[32:35]
    v_mfma_f32_32x32x16_bf16 v[80:95], v[64:67], v[16:19], v[80:95]
    s_barrier
    ds_write_b128 v52, v[20:23] offset:160
    ds_write_b128 v52, v[24:27] offset:176
    ds_write_b128 v52, v[28:31] offset:192
    s_nop 6
    s_nop 0
    v_max3_f32 v36, v80, v81, v82
    v_min3_f32 v37, v80, v81, v82
    v_max3_f32 v36, v36, v83, v84
    v_min3_f32 v37, v37, v83, v84
    v_max3_f32 v36, v36, v85, v86
    v_min3_f32 v37, v37, v85, v86
    v_max3_f32 v36, v36, v87, v88
    v_min3_f32 v37, v37, v87, v88
    v_max3_f32 v36, v36, v89, v90
    v_min3_f32 v37, v37, v89, v90
    v_max3_f32 v36, v36, v91, v92
    v_min3_f32 v37, v37, v91, v92
    v_max3_f32 v36, v36, v93, v94
    v_min3_f32 v37, v37, v93, v94
    v_max3_f32 v36, v36, v95, v32
    v_min3_f32 v37, v37, v95, v32
    v_max3_f32 v36, v36, v33, v34
    v_min3_f32 v37, v37, v33, v34
    v_max_f32 v36, v36, v35
    v_min_f32 v37, v37, v35
    v_mul_f32 v36, s48, v36
    v_mul_f32 v37, s48, v37
    v_fma_f32 v56, v80, s48, -v36
    v_fma_f32 v57, v81, s48, -v36
    v_exp_f32 v56, v56
    s_lshr_b32 s64, s3, 1
    v_exp_f32 v57, v57
    s_mul_i32 s64, s64, 48
    v_fma_f32 v58, v82, s48, -v36
    v_fma_f32 v59, v83, s48, -v36
    v_exp_f32 v58, v58
    s_mul_i32 s65, s3, 40
    v_exp_f32 v59, v59
    s_sub_u32 s64, s64, s65
    v_fma_f32 v60, v84, s48, -v36
    v_fma_f32 v61, v85, s48, -v36
    v_add_f32 v38, v56, v58
    v_add_f32 v39, v57, v59
    v_exp_f32_e64 v60, v60
    s_add_u32 s64, s64, 160
    v_exp_f32 v61, v61
    v_add_u32 v52, s64, v53
    v_fma_f32 v62, v86, s48, -v36
    v_fma_f32 v63, v87, s48, -v36
    v_add_f32 v38, v38, v60
    v_add_f32 v39, v39, v61
    v_exp_f32_e64 v62, v62
    s_mul_i32 s75, s63, 102400
    v_exp_f32_e64 v63, v63
    s_mul_i32 s65, s3, 25600
    v_fma_f32 v64, v88, s48, -v36
    v_fma_f32 v65, v89, s48, -v36
    v_add_f32 v38, v38, v62
    v_add_f32 v39, v39, v63
    v_exp_f32 v64, v64
    s_add_u32 s75, s75, s65
    v_exp_f32_e64 v65, v65
    s_add_u32 s75, s75, 1048576
    v_fma_f32 v66, v90, s48, -v36
    v_fma_f32 v67, v91, s48, -v36
    v_add_f32 v38, v38, v64
    v_add_f32 v39, v39, v65
    v_exp_f32 v66, v66
    s_lshl_b32 s64, s61, 2
    v_exp_f32 v67, v67
    s_add_u32 s64, s64, s3
    v_fma_f32 v68, v92, s48, -v36
    v_fma_f32 v69, v93, s48, -v36
    v_add_f32 v38, v38, v66
    v_add_f32 v39, v39, v67
    v_exp_f32 v68, v68
    s_lshl_b32 s64, s64, 14
    v_exp_f32_e64 v69, v69
    s_add_u32 s64, s64, 2097152
    v_fma_f32 v70, v94, s48, -v36
    v_fma_f32 v71, v95, s48, -v36
    v_add_f32 v38, v38, v68
    v_add_f32 v39, v39, v69
    v_exp_f32 v70, v70
    s_lshl_b32 s65, s60, 10
    v_exp_f32 v71, v71
    s_add_u32 s65, s65, s64
    v_fma_f32 v72, v32, s48, -v36
    v_fma_f32 v73, v33, s48, -v36
    v_add_f32 v38, v38, v70
    v_add_f32 v39, v39, v71
    v_exp_f32 v72, v72
    s_and_b32 s24, s60, 3
    s_mul_i32 s24, s24, 6400
    s_add_u32 s24, s24, s75
    v_lshlrev_b32 v43, 3, v54
    s_mov_b32 m0, 80896
    s_mov_b32 exec_hi, 0x3ffff
    buffer_load_dword v43, s[44:47], s24 offen sc1 lds
    s_mov_b32 exec_hi, -1
    v_exp_f32_e64 v73, v73
    s_lshl_b32 s20, s60, 2
    v_fma_f32 v74, v34, s48, -v36
    v_fma_f32 v75, v35, s48, -v36
    v_add_f32 v38, v38, v72
    v_add_f32 v39, v39, v73
    v_exp_f32 v74, v74
    s_add_u32 s20, s20, s3
    v_exp_f32 v75, v75
    s_lshl_b32 s20, s20, 4
    v_add_f32 v38, v38, v39
    v_add_f32 v38, v38, v74
    v_add_f32 v38, v38, v75
    v_rcp_f32 v38, v38
    s_nop 0
    v_mul_f32 v56, v38, v56
    v_mul_f32_e64 v57, v38, v57
    v_cvt_pk_bf16_f32 v8, v56, v57
    s_add_u32 s20, s20, s61
    v_mul_f32 v58, v38, v58
    v_mul_f32_e64 v59, v38, v59
    v_cvt_pk_bf16_f32 v9, v58, v59
    s_mul_i32 s20, s20, 2560
    v_mul_f32 v60, v38, v60
    v_mul_f32 v61, v38, v61
    v_cvt_pk_bf16_f32 v10, v60, v61
    s_add_u32 s20, s20, 9437184
    v_mul_f32 v62, v38, v62
    v_mul_f32 v63, v38, v63
    v_cvt_pk_bf16_f32 v11, v62, v63
    v_mul_f32 v64, v38, v64
    v_mul_f32 v65, v38, v65
    v_cvt_pk_bf16_f32 v12, v64, v65
    ds_write_b128 v51, v[8:11] offset:0
    v_mul_f32 v66, v38, v66
    v_mul_f32 v67, v38, v67
    v_cvt_pk_bf16_f32 v13, v66, v67
    v_mul_f32 v68, v38, v68
    v_mul_f32 v69, v38, v69
    v_cvt_pk_bf16_f32 v14, v68, v69
    v_mul_f32 v70, v38, v70
    v_mul_f32 v71, v38, v71
    v_cvt_pk_bf16_f32 v15, v70, v71
    v_mul_f32 v72, v38, v72
    v_mul_f32 v73, v38, v73
    v_cvt_pk_bf16_f32 v16, v72, v73
    ds_write_b128 v51, v[12:15] offset:16
    v_mul_f32 v74, v38, v74
    v_mul_f32 v75, v38, v75
    v_cvt_pk_bf16_f32 v17, v74, v75
    v_fma_f32 v80, -v80, s48, v37
    v_fma_f32 v81, -v81, s48, v37
    v_exp_f32 v80, v80
    v_exp_f32 v81, v81
    v_fma_f32 v82, -v82, s48, v37
    v_fma_f32 v83, -v83, s48, v37
    v_exp_f32 v82, v82
    v_exp_f32 v83, v83
    v_fma_f32 v84, -v84, s48, v37
    v_fma_f32 v85, -v85, s48, v37
    v_add_f32 v38, v80, v82
    v_add_f32 v39, v81, v83
    v_exp_f32 v84, v84
    v_exp_f32 v85, v85
    v_fma_f32 v86, -v86, s48, v37
    v_fma_f32 v87, -v87, s48, v37
    v_add_f32 v38, v38, v84
    v_add_f32 v39, v39, v85
    v_exp_f32 v86, v86
    v_exp_f32 v87, v87
    v_fma_f32 v88, -v88, s48, v37
    v_fma_f32 v89, -v89, s48, v37
    v_add_f32 v38, v38, v86
    v_add_f32 v39, v39, v87
    v_exp_f32 v88, v88
    v_exp_f32 v89, v89
    v_fma_f32 v90, -v90, s48, v37
    v_fma_f32 v91, -v91, s48, v37
    v_add_f32 v38, v38, v88
    v_add_f32 v39, v39, v89
    v_exp_f32 v90, v90
    v_exp_f32 v91, v91
    v_fma_f32 v92, -v92, s48, v37
    v_fma_f32 v93, -v93, s48, v37
    v_add_f32 v38, v38, v90
    v_add_f32 v39, v39, v91
    v_exp_f32 v92, v92
    v_exp_f32 v93, v93
    v_fma_f32 v94, -v94, s48, v37
    v_fma_f32 v95, -v95, s48, v37
    v_add_f32 v38, v38, v92
    v_add_f32 v39, v39, v93
    v_exp_f32 v94, v94
    v_exp_f32 v95, v95
    v_fma_f32 v32, -v32, s48, v37
    v_fma_f32 v33, -v33, s48, v37
    v_add_f32 v38, v38, v94
    v_add_f32 v39, v39, v95
    v_exp_f32 v32, v32
    v_exp_f32 v33, v33
    v_fma_f32 v34, -v34, s48, v37
    v_fma_f32 v35, -v35, s48, v37
    v_add_f32 v38, v38, v32
    v_add_f32 v39, v39, v33
    v_exp_f32 v34, v34
    v_exp_f32 v35, v35
    v_add_f32 v38, v38, v39
    v_add_f32 v38, v38, v34
    v_add_f32 v38, v38, v35
    v_rcp_f32 v38, v38
    s_nop 0
    v_mul_f32 v80, v38, v80
    v_mul_f32_e64 v81, v38, v81
    v_cvt_pk_bf16_f32 v18, v80, v81
    v_mul_f32 v82, v38, v82
    v_mul_f32 v83, v38, v83
    v_cvt_pk_bf16_f32 v19, v82, v83
    ds_write_b128 v51, v[16:19] offset:32
    v_mul_f32 v84, v38, v84
    v_mul_f32 v85, v38, v85
    v_cvt_pk_bf16_f32 v20, v84, v85
    v_mul_f32 v86, v38, v86
    v_mul_f32 v87, v38, v87
    v_cvt_pk_bf16_f32 v21, v86, v87
    v_mul_f32 v88, v38, v88
    v_mul_f32 v89, v38, v89
    v_cvt_pk_bf16_f32 v22, v88, v89
    v_mul_f32 v90, v38, v90
    v_mul_f32 v91, v38, v91
    v_cvt_pk_bf16_f32 v23, v90, v91
    ds_write_b128 v51, v[20:23] offset:48
    v_mul_f32 v92, v38, v92
    v_mul_f32 v93, v38, v93
    v_cvt_pk_bf16_f32 v24, v92, v93
    v_mul_f32 v94, v38, v94
    v_mul_f32 v95, v38, v95
    v_cvt_pk_bf16_f32 v25, v94, v95
    v_mul_f32 v32, v38, v32
    v_mul_f32 v33, v38, v33
    v_cvt_pk_bf16_f32 v26, v32, v33
    v_mul_f32_e64 v34, v38, v34
    v_mul_f32 v35, v38, v35
    v_cvt_pk_bf16_f32 v27, v34, v35
    ds_write_b128 v51, v[24:27] offset:64
    v_add_u32 v51, 16384, v54
    s_waitcnt vmcnt(1)
    s_waitcnt lgkmcnt(0)
    s_barrier
    ds_read_b64_tr_b16 v[56:57], v53 offset:0
    ds_read_b64_tr_b16 v[58:59], v53 offset:272
    ds_read_b64_tr_b16 v[60:61], v52 offset:0
    ds_read_b64_tr_b16 v[62:63], v52 offset:272
    ds_read_b64_tr_b16 v[64:65], v53 offset:4352
    ds_read_b64_tr_b16 v[66:67], v53 offset:4624
    ds_read_b64_tr_b16 v[68:69], v52 offset:4352
    ds_read_b64_tr_b16 v[70:71], v52 offset:4624
    ds_read_b64_tr_b16 v[72:73], v53 offset:8704
    ds_read_b64_tr_b16 v[74:75], v53 offset:8976
    ds_read_b64_tr_b16 v[76:77], v52 offset:8704
    ds_read_b64_tr_b16 v[78:79], v52 offset:8976
    s_waitcnt lgkmcnt(8)
    v_mfma_f32_32x32x16_bf16 v[80:95], v[56:59], v[60:63], 0
    ds_read_b64_tr_b16 v[8:9], v53 offset:13056
    ds_read_b64_tr_b16 v[10:11], v53 offset:13328
    ds_read_b64_tr_b16 v[12:13], v52 offset:13056
    ds_read_b64_tr_b16 v[14:15], v52 offset:13328
    s_waitcnt lgkmcnt(8)
    v_mfma_f32_32x32x16_bf16 v[80:95], v[64:67], v[68:71], v[80:95]
    ds_read_b64_tr_b16 v[56:57], v53 offset:17408
    ds_read_b64_tr_b16 v[58:59], v53 offset:17680
L_pageB1:
    s_cbranch_execz L_warmB
    s_nop 0
    ds_read_b64_tr_b16 v[60:61], v52 offset:17408
    ds_read_b64_tr_b16 v[62:63], v52 offset:17680
    s_waitcnt lgkmcnt(8)
    v_mfma_f32_32x32x16_bf16 v[80:95], v[72:75], v[76:79], v[80:95]
    ds_read_b64_tr_b16 v[64:65], v53 offset:21760
    ds_read_b64_tr_b16 v[66:67], v53 offset:22032
    ds_read_b64_tr_b16 v[68:69], v52 offset:21760
    ds_read_b64_tr_b16 v[70:71], v52 offset:22032
    s_waitcnt lgkmcnt(8)
    v_mfma_f32_32x32x16_bf16 v[80:95], v[8:11], v[12:15], v[80:95]
    ds_read_b64_tr_b16 v[72:73], v53 offset:26112
    ds_read_b64_tr_b16 v[74:75], v53 offset:26384
    ds_read_b64_tr_b16 v[76:77], v52 offset:26112
    ds_read_b64_tr_b16 v[78:79], v52 offset:26384
    s_waitcnt lgkmcnt(8)
    v_mfma_f32_32x32x16_bf16 v[80:95], v[56:59], v[60:63], v[80:95]
    ds_read_b64_tr_b16 v[8:9], v53 offset:30464
    ds_read_b64_tr_b16 v[10:11], v53 offset:30736
    ds_read_b64_tr_b16 v[12:13], v52 offset:30464
    ds_read_b64_tr_b16 v[14:15], v52 offset:30736
    s_waitcnt lgkmcnt(8)
    v_mfma_f32_32x32x16_bf16 v[80:95], v[64:67], v[68:71], v[80:95]
    ds_read_b128 v[28:31], v51 offset:24576
    ds_read_b128 v[32:35], v51 offset:25600
    ds_read_b128 v[36:39], v51 offset:26624
    ds_read_b128 v[40:43], v51 offset:27648
    ds_read_b128 v[16:19], v51 offset:28672
    s_waitcnt lgkmcnt(9)
    v_mfma_f32_32x32x16_bf16 v[80:95], v[72:75], v[76:79], v[80:95]
    v_and_b32 v53, 31, v0
    v_bfe_u32 v52, v0, 5, 1
    v_mad_u32_u24 v52, v52, 22, v53
    v_lshlrev_b32 v52, 4, v52
    s_waitcnt lgkmcnt(5)
    v_mfma_f32_32x32x16_bf16 v[80:95], v[8:11], v[12:15], v[80:95]
    s_waitcnt lgkmcnt(4)
    v_mfma_f32_16x16x32_bf16 v[56:59], v[28:31], v[96:99], 0
    ds_read_b128 v[20:23], v51 offset:29696
    v_mfma_f32_16x16x32_bf16 v[60:63], v[28:31], v[100:103], 0
    s_waitcnt lgkmcnt(4)
    v_mfma_f32_16x16x32_bf16 v[68:71], v[32:35], v[100:103], 0
    ds_read_b128 v[24:27], v51 offset:30720
    s_nop 3
    s_nop 0
    v_cvt_pk_bf16_f32 v8, v80, v81
    v_cvt_pk_bf16_f32 v9, v82, v83
    v_cvt_pk_bf16_f32 v10, v84, v85
    v_cvt_pk_bf16_f32 v11, v86, v87
    v_cvt_pk_bf16_f32 v12, v88, v89
    v_cvt_pk_bf16_f32 v13, v90, v91
    s_mov_b32 exec_lo, 0x3fffff
    s_mov_b32 exec_hi, 0x3fffff
    buffer_store_dwordx4 v[8:11], v52, s[44:47], s65 offen sc1
    s_mov_b32 exec_hi, 0
    buffer_store_dwordx2 v[12:13], v55, s[44:47], s65 offen offset:704 sc1
    s_mov_b64 exec, -1
    s_barrier
    v_mfma_f32_16x16x32_bf16 v[64:67], v[32:35], v[96:99], 0
    s_add_u32 m0, s67, 16384
    s_waitcnt lgkmcnt(4)
    v_mfma_f32_16x16x32_bf16 v[72:75], v[36:39], v[96:99], 0
    ds_read_b128 v[28:31], v51 offset:31744
    s_add_u32 s71, s71, 4096
    v_mfma_f32_16x16x32_bf16 v[76:79], v[36:39], v[100:103], 0
    s_sub_u32 s66, s71, 61440
    s_waitcnt lgkmcnt(4)
    v_mfma_f32_16x16x32_bf16 v[56:59], v[40:43], v[104:107], v[56:59]
    ds_read_b128 v[32:35], v51 offset:32768
    s_min_u32 s71, s71, s66
    v_mfma_f32_16x16x32_bf16 v[60:63], v[40:43], v[108:111], v[60:63]
    buffer_load_dwordx4 v54, s[52:55], s71 offen sc1 lds
    s_waitcnt lgkmcnt(4)
    v_mfma_f32_16x16x32_bf16 v[68:71], v[16:19], v[108:111], v[68:71]
    ds_read_b128 v[36:39], v51 offset:33792
    s_add_u32 m0, s67, 20480
    v_mfma_f32_16x16x32_bf16 v[64:67], v[16:19], v[104:107], v[64:67]
    s_add_u32 s71, s71, 4096
    s_waitcnt lgkmcnt(4)
    v_mfma_f32_16x16x32_bf16 v[72:75], v[20:23], v[104:107], v[72:75]
    ds_read_b128 v[40:43], v51 offset:34816
    s_sub_u32 s66, s71, 61440
    v_mfma_f32_16x16x32_bf16 v[76:79], v[20:23], v[108:111], v[76:79]
    s_min_u32 s71, s71, s66
    s_waitcnt lgkmcnt(4)
    v_mfma_f32_16x16x32_bf16 v[56:59], v[24:27], v[112:115], v[56:59]
    ds_read_b128 v[16:19], v51 offset:35840
    buffer_load_dwordx4 v54, s[52:55], s71 offen sc1 lds
    v_mfma_f32_16x16x32_bf16 v[60:63], v[24:27], v[116:119], v[60:63]
    s_add_u32 m0, s67, 24576
    s_waitcnt lgkmcnt(4)
    v_mfma_f32_16x16x32_bf16 v[68:71], v[28:31], v[116:119], v[68:71]
    ds_read_b128 v[20:23], v51 offset:36864
    s_add_u32 s71, s71, 4096
    v_mfma_f32_16x16x32_bf16 v[64:67], v[28:31], v[112:115], v[64:67]
    s_sub_u32 s66, s71, 61440
    s_waitcnt lgkmcnt(4)
    v_mfma_f32_16x16x32_bf16 v[72:75], v[32:35], v[112:115], v[72:75]
    ds_read_b128 v[24:27], v51 offset:37888
    s_min_u32 s71, s71, s66
    v_mfma_f32_16x16x32_bf16 v[76:79], v[32:35], v[116:119], v[76:79]
    buffer_load_dwordx4 v54, s[52:55], s71 offen sc1 lds
    s_waitcnt lgkmcnt(4)
    v_mfma_f32_16x16x32_bf16 v[56:59], v[36:39], v[120:123], v[56:59]
    ds_read_b128 v[28:31], v51 offset:38912
    s_add_u32 m0, s67, 28672
    v_mfma_f32_16x16x32_bf16 v[60:63], v[36:39], v[124:127], v[60:63]
    s_add_u32 s71, s71, 4096
    s_waitcnt lgkmcnt(4)
    s_nop 0
    v_mfma_f32_16x16x32_bf16 v[68:71], v[40:43], v[124:127], v[68:71]
    ds_read_b128 v[32:35], v51 offset:39936
    s_sub_u32 s66, s71, 61440
    v_mfma_f32_16x16x32_bf16 v[64:67], v[40:43], v[120:123], v[64:67]
    s_min_u32 s71, s71, s66
    s_waitcnt lgkmcnt(4)
    v_mfma_f32_16x16x32_bf16 v[72:75], v[16:19], v[120:123], v[72:75]
    ds_read_b128 v[36:39], v51 offset:40960
    buffer_load_dwordx4 v54, s[52:55], s71 offen sc1 lds
    v_mfma_f32_16x16x32_bf16 v[76:79], v[16:19], v[124:127], v[76:79]
    s_add_u32 m0, s67, 32768
    s_waitcnt lgkmcnt(4)
    v_mfma_f32_16x16x32_bf16 v[56:59], v[20:23], v[128:131], v[56:59]
    ds_read_b128 v[40:43], v51 offset:41984
    s_add_u32 s71, s71, 4096
    v_mfma_f32_16x16x32_bf16 v[60:63], v[20:23], v[132:135], v[60:63]
    s_sub_u32 s66, s71, 61440
    s_waitcnt lgkmcnt(4)
    v_mfma_f32_16x16x32_bf16 v[68:71], v[24:27], v[132:135], v[68:71]
    ds_read_b128 v[16:19], v51 offset:43008
    s_min_u32 s71, s71, s66
    v_mfma_f32_16x16x32_bf16 v[64:67], v[24:27], v[128:131], v[64:67]
    buffer_load_dwordx4 v54, s[52:55], s71 offen sc1 lds
    s_waitcnt lgkmcnt(4)
    v_mfma_f32_16x16x32_bf16 v[72:75], v[28:31], v[128:131], v[72:75]
    ds_read_b128 v[20:23], v51 offset:44032
    s_add_u32 m0, s67, 36864
    v_mfma_f32_16x16x32_bf16 v[76:79], v[28:31], v[132:135], v[76:79]
    s_add_u32 s71, s71, 4096
    s_waitcnt lgkmcnt(4)
    s_nop 0
    v_mfma_f32_16x16x32_bf16 v[56:59], v[32:35], v[136:139], v[56:59]
    ds_read_b128 v[24:27], v51 offset:45056
    s_sub_u32 s66, s71, 61440
    v_mfma_f32_16x16x32_bf16 v[60:63], v[32:35], v[140:143], v[60:63]
    s_min_u32 s71, s71, s66
    s_waitcnt lgkmcnt(4)
    v_mfma_f32_16x16x32_bf16 v[68:71], v[36:39], v[140:143], v[68:71]
    ds_read_b128 v[28:31], v51 offset:46080
    buffer_load_dwordx4 v54, s[52:55], s71 offen sc1 lds
    v_mfma_f32_16x16x32_bf16 v[64:67], v[36:39], v[136:139], v[64:67]
    s_add_u32 s24, s60, 0
    s_waitcnt lgkmcnt(4)
    v_mfma_f32_16x16x32_bf16 v[72:75], v[40:43], v[136:139], v[72:75]
    ds_read_b128 v[32:35], v51 offset:47104
    s_and_b32 s24, s24, 3
    v_mfma_f32_16x16x32_bf16 v[76:79], v[40:43], v[140:143], v[76:79]
    s_mul_i32 s24, s24, 5120
    s_waitcnt lgkmcnt(4)
    v_mfma_f32_16x16x32_bf16 v[56:59], v[16:19], v[144:147], v[56:59]
    ds_read_b128 v[36:39], v51 offset:48128
    s_add_u32 s24, s24, s75
    v_mfma_f32_16x16x32_bf16 v[60:63], v[16:19], v[148:151], v[60:63]
    buffer_load_dwordx4 v[96:99], v54, s[44:47], s24 offen offset:0 sc1
    s_waitcnt lgkmcnt(4)
    v_mfma_f32_16x16x32_bf16 v[68:71], v[20:23], v[148:151], v[68:71]
    ds_read_b128 v[40:43], v51 offset:49152
    buffer_load_dwordx4 v[100:103], v54, s[44:47], s24 offen offset:1024 sc1
    v_mfma_f32_16x16x32_bf16 v[64:67], v[20:23], v[144:147], v[64:67]
    s_waitcnt lgkmcnt(4)
    v_mfma_f32_16x16x32_bf16 v[72:75], v[24:27], v[144:147], v[72:75]
    ds_read_b128 v[16:19], v51 offset:50176
    buffer_load_dwordx4 v[104:107], v54, s[44:47], s24 offen offset:2048 sc1
    s_waitcnt vmcnt(9)
    s_atomic_add_x2 s[6:7], s[32:33], s30
    v_mfma_f32_16x16x32_bf16 v[76:79], v[24:27], v[148:151], v[76:79]
    s_waitcnt lgkmcnt(4)
    v_mfma_f32_16x16x32_bf16 v[56:59], v[28:31], v[152:155], v[56:59]
    ds_read_b128 v[20:23], v51 offset:51200
    v_mfma_f32_16x16x32_bf16 v[60:63], v[28:31], v[156:159], v[60:63]
    s_waitcnt lgkmcnt(4)
    v_mfma_f32_16x16x32_bf16 v[68:71], v[32:35], v[156:159], v[68:71]
    ds_read_b128 v[24:27], v51 offset:52224
    s_mov_b64 s[8:9], 0
    s_atomic_umax_x2 s[8:9], s[32:33], s30 glc
    v_mfma_f32_16x16x32_bf16 v[64:67], v[32:35], v[152:155], v[64:67]
    buffer_load_dwordx4 v[108:111], v54, s[44:47], s24 offen offset:3072 sc1
    s_waitcnt lgkmcnt(4)
    v_mfma_f32_16x16x32_bf16 v[72:75], v[36:39], v[152:155], v[72:75]
    ds_read_b128 v[28:31], v51 offset:53248
    v_mfma_f32_16x16x32_bf16 v[76:79], v[36:39], v[156:159], v[76:79]
    s_waitcnt lgkmcnt(4)
    v_mfma_f32_16x16x32_bf16 v[56:59], v[40:43], v[160:163], v[56:59]
    ds_read_b128 v[32:35], v51 offset:54272
    v_mfma_f32_16x16x32_bf16 v[60:63], v[40:43], v[164:167], v[60:63]
    s_waitcnt lgkmcnt(4)
    v_mfma_f32_16x16x32_bf16 v[68:71], v[16:19], v[164:167], v[68:71]
    ds_read_b128 v[36:39], v51 offset:55296
    s_add_u32 s24, s24, 4096
    v_mfma_f32_16x16x32_bf16 v[64:67], v[16:19], v[160:163], v[64:67]
    buffer_load_dwordx4 v[112:115], v54, s[44:47], s24 offen offset:0 sc1
    s_waitcnt lgkmcnt(4)
    v_mfma_f32_16x16x32_bf16 v[72:75], v[20:23], v[160:163], v[72:75]
    ds_read_b128 v[40:43], v51 offset:56320
    v_mfma_f32_16x16x32_bf16 v[76:79], v[20:23], v[164:167], v[76:79]
    s_waitcnt lgkmcnt(4)
    v_mfma_f32_16x16x32_bf16 v[56:59], v[24:27], v[168:171], v[56:59]
    ds_read_b128 v[16:19], v51 offset:57344
    v_mfma_f32_16x16x32_bf16 v[60:63], v[24:27], v[172:175], v[60:63]
    s_add_u32 s24, s60, 1
    s_waitcnt lgkmcnt(4)
    v_mfma_f32_16x16x32_bf16 v[68:71], v[28:31], v[172:175], v[68:71]
    ds_read_b128 v[20:23], v51 offset:58368
    s_and_b32 s24, s24, 3
    v_mfma_f32_16x16x32_bf16 v[64:67], v[28:31], v[168:171], v[64:67]
    s_mul_i32 s24, s24, 5120
    s_waitcnt lgkmcnt(4)
    v_mfma_f32_16x16x32_bf16 v[72:75], v[32:35], v[168:171], v[72:75]
    ds_read_b128 v[24:27], v51 offset:59392
    s_add_u32 s24, s24, s75
    v_mfma_f32_16x16x32_bf16 v[76:79], v[32:35], v[172:175], v[76:79]
    buffer_load_dwordx4 v[116:119], v54, s[44:47], s24 offen offset:0 sc1
    s_waitcnt lgkmcnt(4)
    v_mfma_f32_16x16x32_bf16 v[56:59], v[36:39], v[176:179], v[56:59]
    ds_read_b128 v[28:31], v51 offset:60416
    buffer_load_dwordx4 v[120:123], v54, s[44:47], s24 offen offset:1024 sc1
    v_mfma_f32_16x16x32_bf16 v[60:63], v[36:39], v[180:183], v[60:63]
    s_waitcnt vmcnt(7)
    s_barrier
    s_waitcnt lgkmcnt(4)
    v_mfma_f32_16x16x32_bf16 v[68:71], v[40:43], v[180:183], v[68:71]
    ds_read_b128 v[32:35], v51 offset:0
    v_mfma_f32_16x16x32_bf16 v[64:67], v[40:43], v[176:179], v[64:67]
    s_waitcnt lgkmcnt(4)
    v_mfma_f32_16x16x32_bf16 v[72:75], v[16:19], v[176:179], v[72:75]
    ds_read_b128 v[36:39], v51 offset:1024
    v_mfma_f32_16x16x32_bf16 v[76:79], v[16:19], v[180:183], v[76:79]
    buffer_load_dwordx4 v[124:127], v54, s[44:47], s24 offen offset:2048 sc1
    s_waitcnt lgkmcnt(4)
    v_mfma_f32_16x16x32_bf16 v[56:59], v[20:23], v[184:187], v[56:59]
    ds_read_b128 v[40:43], v51 offset:2048
    v_mfma_f32_16x16x32_bf16 v[60:63], v[20:23], v[188:191], v[60:63]
    s_waitcnt lgkmcnt(4)
    v_mfma_f32_16x16x32_bf16 v[68:71], v[24:27], v[188:191], v[68:71]
    ds_read_b128 v[16:19], v51 offset:3072
    v_mfma_f32_16x16x32_bf16 v[64:67], v[24:27], v[184:187], v[64:67]
    s_waitcnt lgkmcnt(4)
    v_mfma_f32_16x16x32_bf16 v[72:75], v[28:31], v[184:187], v[72:75]
    ds_read_b128 v[20:23], v51 offset:4096
    ds_read_b64_tr_b16 v[80:81], v49 offset:0
    v_mfma_f32_16x16x32_bf16 v[76:79], v[28:31], v[188:191], v[76:79]
    ds_read_b64_tr_b16 v[82:83], v49 offset:160
    s_waitcnt lgkmcnt(6)
    v_mfma_f32_16x16x32_bf16 v[56:59], v[32:35], v[192:195], v[56:59]
    ds_read_b128 v[24:27], v51 offset:5120
    ds_read_b64_tr_b16 v[84:85], v49 offset:320
    v_mfma_f32_16x16x32_bf16 v[60:63], v[32:35], v[196:199], v[60:63]
    ds_read_b64_tr_b16 v[86:87], v49 offset:480
    s_waitcnt lgkmcnt(8)
    s_nop 0
    v_mfma_f32_16x16x32_bf16 v[68:71], v[36:39], v[196:199], v[68:71]
    ds_read_b128 v[28:31], v51 offset:6144
    ds_read_b64_tr_b16 v[88:89], v49 offset:640
    v_mfma_f32_16x16x32_bf16 v[64:67], v[36:39], v[192:195], v[64:67]
    v_mov_b32 v90, 0
    s_waitcnt lgkmcnt(9)
    v_mfma_f32_16x16x32_bf16 v[72:75], v[40:43], v[192:195], v[72:75]
    ds_read_b128 v[32:35], v51 offset:7168
    v_mov_b32 v91, 0
    v_mfma_f32_16x16x32_bf16 v[76:79], v[40:43], v[196:199], v[76:79]
    s_waitcnt lgkmcnt(9)
    v_mfma_f32_16x16x32_bf16 v[56:59], v[16:19], v[200:203], v[56:59]
    ds_read_b128 v[36:39], v51 offset:8192
    v_mfma_f32_16x16x32_bf16 v[60:63], v[16:19], v[204:207], v[60:63]
    s_waitcnt lgkmcnt(9)
    v_mfma_f32_16x16x32_bf16 v[68:71], v[20:23], v[204:207], v[68:71]
    ds_read_b128 v[40:43], v51 offset:9216
    v_mfma_f32_16x16x32_bf16 v[64:67], v[20:23], v[200:203], v[64:67]
    s_waitcnt lgkmcnt(7)
    v_mfma_f32_16x16x32_bf16 v[72:75], v[24:27], v[200:203], v[72:75]
    ds_read_b128 v[16:19], v51 offset:10240
    v_mfma_f32_16x16x32_bf16 v[76:79], v[24:27], v[204:207], v[76:79]
    s_waitcnt lgkmcnt(5)
    v_mfma_f32_16x16x32_bf16 v[56:59], v[28:31], v[208:211], v[56:59]
    ds_read_b128 v[20:23], v51 offset:11264
    v_mfma_f32_16x16x32_bf16 v[60:63], v[28:31], v[212:215], v[60:63]
    ds_read_b64_tr_b16 v[192:193], v50 offset:0
    s_waitcnt lgkmcnt(5)
    v_mfma_f32_16x16x32_bf16 v[68:71], v[32:35], v[212:215], v[68:71]
    ds_read_b128 v[24:27], v51 offset:12288
    ds_read_b64_tr_b16 v[194:195], v50 offset:160
    v_mfma_f32_16x16x32_bf16 v[64:67], v[32:35], v[208:211], v[64:67]
    ds_read_b64_tr_b16 v[196:197], v50 offset:320
    s_waitcnt lgkmcnt(7)
    v_mfma_f32_16x16x32_bf16 v[72:75], v[36:39], v[208:211], v[72:75]
    ds_read_b128 v[28:31], v51 offset:13312
    ds_read_b64_tr_b16 v[198:199], v50 offset:480
    v_mfma_f32_16x16x32_bf16 v[76:79], v[36:39], v[212:215], v[76:79]
    ds_read_b64_tr_b16 v[200:201], v50 offset:640
    s_waitcnt lgkmcnt(9)
    v_mfma_f32_16x16x32_bf16 v[56:59], v[40:43], v[216:219], v[56:59]
    ds_read_b128 v[32:35], v51 offset:14336
    v_mov_b32_e64 v202, 0
    v_mfma_f32_16x16x32_bf16 v[60:63], v[40:43], v[220:223], v[60:63]
    v_mov_b32 v203, 0
    s_waitcnt lgkmcnt(9)
    v_mfma_f32_16x16x32_bf16 v[68:71], v[16:19], v[220:223], v[68:71]
    ds_read_b128 v[36:39], v51 offset:15360
    s_sub_u32 s14, s8, s34
    s_subb_u32 s15, s9, s35
    s_xor_b32 s14, s14, 16
    s_or_b32 s14, s14, s15
    s_cbranch_scc0 L_as21
    s_waitcnt lgkmcnt(0)
    s_sub_u32 s8, s8, s34
    s_subb_u32 s9, s9, s35
    s_xor_b32 s8, s8, 16
    s_or_b32 s8, s8, s9
    s_cbranch_scc0 L_got22
    s_mov_b32 s72, 0
L_spin22:
    s_mov_b64 s[8:9], 0
    s_atomic_add_x2 s[8:9], s[32:33], s30 glc
    s_add_u32 s72, s72, 1
    s_cmp_ge_u32 s72, 131072
    s_waitcnt lgkmcnt(0)
    s_cbranch_scc1 L_got22
    s_sub_u32 s8, s8, s34
    s_subb_u32 s9, s9, s35
    s_xor_b32 s8, s8, 16
    s_or_b32 s8, s8, s9
    s_cbranch_scc1 L_spin22
L_got22:
L_as21:
    v_mfma_f32_16x16x32_bf16 v[64:67], v[16:19], v[216:219], v[64:67]
    s_add_u32 s65, s60, 0
    s_waitcnt lgkmcnt(9)
    v_mfma_f32_16x16x32_bf16 v[72:75], v[20:23], v[216:219], v[72:75]
    ds_read_b128 v[40:43], v51 offset:16384
    s_and_b32 s65, s65, 3
    v_mfma_f32_16x16x32_bf16 v[76:79], v[20:23], v[220:223], v[76:79]
    s_lshl_b32 s65, s65, 12
    s_waitcnt lgkmcnt(8)
    v_mfma_f32_16x16x32_bf16 v[56:59], v[24:27], v[224:227], v[56:59]
    ds_read_b128 v[16:19], v51 offset:17408
    s_add_u32 s65, s65, s64
    v_mfma_f32_16x16x32_bf16 v[60:63], v[24:27], v[228:231], v[60:63]
    buffer_load_dwordx4 v[128:131], v1, s[44:47], s65 offen offset:0 sc1
    s_waitcnt lgkmcnt(6)
    v_mfma_f32_16x16x32_bf16 v[68:71], v[28:31], v[228:231], v[68:71]
    ds_read_b128 v[20:23], v51 offset:18432
    buffer_load_dwordx4 v[132:135], v2, s[44:47], s65 offen offset:0 sc1
    v_mfma_f32_16x16x32_bf16 v[64:67], v[28:31], v[224:227], v[64:67]
    buffer_load_dwordx4 v[136:139], v1, s[44:47], s65 offen offset:2048 sc1
    s_waitcnt lgkmcnt(4)
    v_mfma_f32_16x16x32_bf16 v[72:75], v[32:35], v[224:227], v[72:75]
    ds_read_b128 v[24:27], v51 offset:19456
    buffer_load_dwordx4 v[140:143], v2, s[44:47], s65 offen offset:2048 sc1
    v_mfma_f32_16x16x32_bf16 v[76:79], v[32:35], v[228:231], v[76:79]
    s_add_u32 s65, s60, 1
    s_waitcnt lgkmcnt(4)
    v_mfma_f32_16x16x32_bf16 v[56:59], v[36:39], v[232:235], v[56:59]
    ds_read_b128 v[28:31], v51 offset:20480
    s_and_b32 s65, s65, 3
    v_mfma_f32_16x16x32_bf16 v[60:63], v[36:39], v[236:239], v[60:63]
    s_lshl_b32 s65, s65, 12
    s_waitcnt lgkmcnt(4)
    v_mfma_f32_16x16x32_bf16 v[68:71], v[40:43], v[236:239], v[68:71]
    ds_read_b128 v[32:35], v51 offset:21504
    s_add_u32 s65, s65, s64
    v_mfma_f32_16x16x32_bf16 v[64:67], v[40:43], v[232:235], v[64:67]
    buffer_load_dwordx4 v[144:147], v1, s[44:47], s65 offen offset:0 sc1
    s_waitcnt lgkmcnt(4)
    v_mfma_f32_16x16x32_bf16 v[72:75], v[16:19], v[232:235], v[72:75]
    ds_read_b128 v[36:39], v51 offset:22528
    buffer_load_dwordx4 v[148:151], v2, s[44:47], s65 offen offset:0 sc1
    v_mfma_f32_16x16x32_bf16 v[76:79], v[16:19], v[236:239], v[76:79]
    buffer_load_dwordx4 v[152:155], v1, s[44:47], s65 offen offset:2048 sc1
    s_waitcnt lgkmcnt(4)
    s_nop 0
    v_mfma_f32_16x16x32_bf16 v[56:59], v[20:23], v[240:243], v[56:59]
    ds_read_b128 v[40:43], v51 offset:23552
    buffer_load_dwordx4 v[156:159], v2, s[44:47], s65 offen offset:2048 sc1
    v_mfma_f32_16x16x32_bf16 v[60:63], v[20:23], v[244:247], v[60:63]
    s_add_u32 s65, s60, 2
    s_waitcnt lgkmcnt(4)
    v_mfma_f32_16x16x32_bf16 v[68:71], v[24:27], v[244:247], v[68:71]
    s_and_b32 s65, s65, 3
    s_lshl_b32 s65, s65, 12
    v_mfma_f32_16x16x32_bf16 v[64:67], v[24:27], v[240:243], v[64:67]
    s_add_u32 s65, s65, s64
    s_waitcnt lgkmcnt(3)
    v_mfma_f32_16x16x32_bf16 v[72:75], v[28:31], v[240:243], v[72:75]
    buffer_load_dwordx4 v[160:163], v1, s[44:47], s65 offen offset:0 sc1
    v_mov_b32_e64 v14, 0
    v_mfma_f32_16x16x32_bf16 v[76:79], v[28:31], v[244:247], v[76:79]
    v_mov_b32 v15, 0
    s_waitcnt lgkmcnt(2)
    v_mfma_f32_16x16x32_bf16 v[56:59], v[32:35], v[248:251], v[56:59]
    buffer_load_dwordx4 v[164:167], v2, s[44:47], s65 offen offset:0 sc1
    v_mfma_f32_16x16x32_bf16 v[60:63], v[32:35], v[252:255], v[60:63]
    s_waitcnt lgkmcnt(1)
    v_mfma_f32_16x16x32_bf16 v[68:71], v[36:39], v[252:255], v[68:71]
    v_mfma_f32_16x16x32_bf16 v[64:67], v[36:39], v[248:251], v[64:67]
    s_waitcnt lgkmcnt(0)
    v_mfma_f32_16x16x32_bf16 v[72:75], v[40:43], v[248:251], v[72:75]
    v_mfma_f32_16x16x32_bf16 v[76:79], v[40:43], v[252:255], v[76:79]
    buffer_load_dwordx4 v[168:171], v1, s[44:47], s65 offen offset:2048 sc1
    buffer_load_dwordx4 v[172:175], v2, s[44:47], s65 offen offset:2048 sc1
    v_cvt_pk_bf16_f32 v8, v56, v57
    v_cvt_pk_bf16_f32 v9, v58, v59
    v_cvt_pk_bf16_f32 v16, v60, v61
    v_cvt_pk_bf16_f32 v17, v62, v63
    v_cvt_pk_bf16_f32 v10, v64, v65
    v_cvt_pk_bf16_f32 v11, v66, v67
    v_cvt_pk_bf16_f32 v18, v68, v69
    v_cvt_pk_bf16_f32 v19, v70, v71
    v_permlane16_swap_b32 v8, v16
    v_permlane16_swap_b32 v9, v17
    v_permlane16_swap_b32 v10, v18
    v_permlane16_swap_b32 v11, v19
    v_cvt_pk_bf16_f32 v12, v72, v73
    v_cvt_pk_bf16_f32 v13, v74, v75
    v_cvt_pk_bf16_f32 v20, v76, v77
    v_cvt_pk_bf16_f32 v21, v78, v79
    v_mov_b32 v43, v72
    s_mov_b32 exec_lo, 0
    v_mov_b32 v43, v76
    s_mov_b32 exec_lo, 0xffff0000
    s_mov_b32 exec_hi, 0xffff0000
    ds_write_b32 v48, v43
    s_mov_b64 exec, -1
    v_mfma_f32_16x16x32_bf16 v[72:75], v[192:195], v[8:11], 0
    v_mfma_f32_32x32x16_bf16 v[56:71], v[80:83], v[8:11], 0
    v_permlane16_swap_b32 v12, v20
    v_permlane16_swap_b32 v13, v21
    v_mfma_f32_16x16x32_bf16 v[72:75], v[196:199], v[16:19], v[72:75]
    v_mfma_f32_32x32x16_bf16 v[56:71], v[84:87], v[16:19], v[56:71]
    v_mfma_f32_16x16x32_bf16 v[72:75], v[200:203], v[12:15], v[72:75]
    v_mfma_f32_32x32x16_bf16 v[56:71], v[88:91], v[12:15], v[56:71]
    s_add_u32 s65, s60, 3
    s_and_b32 s65, s65, 3
    s_lshl_b32 s65, s65, 12
    s_add_u32 s65, s65, s64
    buffer_load_dwordx4 v[176:179], v1, s[44:47], s65 offen offset:0 sc1
    buffer_load_dwordx4 v[180:183], v2, s[44:47], s65 offen offset:0 sc1
    buffer_load_dwordx4 v[184:187], v1, s[44:47], s65 offen offset:2048 sc1
    buffer_load_dwordx4 v[188:191], v2, s[44:47], s65 offen offset:2048 sc1
    s_nop 2
    s_nop 0
    v_max3_f32 v36, v56, v57, v58
    v_min3_f32 v38, v56, v57, v58
    v_max3_f32 v36, v36, v59, v60
    v_min3_f32 v38, v38, v59, v60
    v_max3_f32 v36, v36, v61, v62
    v_min3_f32 v38, v38, v61, v62
    v_max3_f32 v36, v36, v63, v64
    v_min3_f32 v38, v38, v63, v64
    v_max3_f32 v36, v36, v65, v66
    v_min3_f32 v38, v38, v65, v66
    v_max3_f32 v36, v36, v67, v68
    v_min3_f32 v38, v38, v67, v68
    v_max3_f32 v36, v36, v69, v70
    v_min3_f32 v38, v38, v69, v70
    v_max3_f32 v36, v36, v71, v72
    v_min3_f32 v38, v38, v71, v72
    v_max3_f32 v36, v36, v73, v74
    v_min3_f32 v38, v38, v73, v74
    v_max_f32 v36, v36, v75
    v_min_f32 v38, v38, v75
    s_mov_b32 s49, s48
    v_mul_f32 v37, s48, v36
    v_mul_f32 v39, s48, v38
    v_mul_f32 v36, s48, v36
    v_mul_f32_e64 v38, s48, v38
    v_pk_fma_f32 v[76:77], v[56:57], s[48:49], v[36:37] neg_lo:[0,0,1] neg_hi:[0,0,1]
    v_exp_f32 v76, v76
    v_exp_f32 v77, v77
    v_pk_fma_f32 v[78:79], v[58:59], s[48:49], v[36:37] neg_lo:[0,0,1] neg_hi:[0,0,1]
    v_exp_f32 v78, v78
    v_exp_f32 v79, v79
    v_pk_fma_f32 v[80:81], v[60:61], s[48:49], v[36:37] neg_lo:[0,0,1] neg_hi:[0,0,1]
    v_pk_add_f32 v[40:41], v[76:77], v[78:79]
    v_exp_f32 v80, v80
    v_exp_f32 v81, v81
    v_pk_fma_f32 v[82:83], v[62:63], s[48:49], v[36:37] neg_lo:[0,0,1] neg_hi:[0,0,1]
    v_pk_add_f32 v[40:41], v[40:41], v[80:81]
    v_exp_f32 v82, v82
    v_exp_f32 v83, v83
    v_pk_fma_f32 v[84:85], v[64:65], s[48:49], v[36:37] neg_lo:[0,0,1] neg_hi:[0,0,1]
    v_pk_add_f32 v[40:41], v[40:41], v[82:83]
    v_exp_f32 v84, v84
    v_exp_f32 v85, v85
    v_pk_fma_f32 v[86:87], v[66:67], s[48:49], v[36:37] neg_lo:[0,0,1] neg_hi:[0,0,1]
    v_pk_add_f32 v[40:41], v[40:41], v[84:85]
    v_exp_f32 v86, v86
    v_exp_f32 v87, v87
    v_pk_fma_f32 v[88:89], v[68:69], s[48:49], v[36:37] neg_lo:[0,0,1] neg_hi:[0,0,1]
    v_pk_add_f32 v[40:41], v[40:41], v[86:87]
    v_exp_f32 v88, v88
    v_exp_f32 v89, v89
    v_pk_fma_f32 v[90:91], v[70:71], s[48:49], v[36:37] neg_lo:[0,0,1] neg_hi:[0,0,1]
    v_pk_add_f32 v[40:41], v[40:41], v[88:89]
    v_exp_f32 v90, v90
    v_exp_f32 v91, v91
    v_pk_fma_f32 v[28:29], v[72:73], s[48:49], v[36:37] neg_lo:[0,0,1] neg_hi:[0,0,1]
    v_pk_add_f32 v[40:41], v[40:41], v[90:91]
    v_exp_f32 v28, v28
    v_exp_f32 v29, v29
    v_pk_fma_f32 v[30:31], v[74:75], s[48:49], v[36:37] neg_lo:[0,0,1] neg_hi:[0,0,1]
    v_pk_add_f32 v[40:41], v[40:41], v[28:29]
    v_exp_f32 v30, v30
    v_exp_f32 v31, v31
    v_add_f32 v40, v40, v41
    v_add_f32 v40, v40, v30
    v_add_f32_e64 v42, v40, v31
    v_cvt_pk_bf16_f32 v8, v76, v77
    buffer_load_dwordx4 v[192:195], v54, s[44:47], s24 offen offset:3072 sc1
    v_cvt_pk_bf16_f32 v9, v78, v79
    s_add_u32 s24, s24, 4096
    v_cvt_pk_bf16_f32 v10, v80, v81
    buffer_load_dwordx4 v[196:199], v54, s[44:47], s24 offen offset:0 sc1
    v_cvt_pk_bf16_f32 v11, v82, v83
    s_add_u32 s24, s60, 2
    v_cvt_pk_bf16_f32 v12, v84, v85
    s_and_b32 s24, s24, 3
    v_cvt_pk_bf16_f32 v13, v86, v87
    s_mul_i32 s24, s24, 5120
    v_cvt_pk_bf16_f32 v14, v88, v89
    s_add_u32 s24, s24, s75
    s_nop 0
    v_cvt_pk_bf16_f32 v15, v90, v91
    buffer_load_dwordx4 v[200:203], v54, s[44:47], s24 offen offset:0 sc1
    v_cvt_pk_bf16_f32 v16, v28, v29
    buffer_load_dwordx4 v[204:207], v54, s[44:47], s24 offen offset:1024 sc1
    v_cvt_pk_bf16_f32 v17, v30, v31
    v_pk_fma_f32 v[56:57], v[56:57], s[48:49], v[38:39] neg_lo:[1,0,0] neg_hi:[1,0,0]
    v_exp_f32 v56, v56
    v_exp_f32 v57, v57
    v_pk_fma_f32 v[58:59], v[58:59], s[48:49], v[38:39] neg_lo:[1,0,0] neg_hi:[1,0,0]
    v_exp_f32 v58, v58
    v_exp_f32 v59, v59
    v_pk_fma_f32 v[60:61], v[60:61], s[48:49], v[38:39] neg_lo:[1,0,0] neg_hi:[1,0,0]
    v_pk_add_f32 v[40:41], v[56:57], v[58:59]
    v_exp_f32 v60, v60
    s_waitcnt vmcnt(18)
    v_mfma_f32_16x16x32_bf16 v[244:247], v[44:47], v[128:131], 0
    v_mfma_f32_16x16x32_bf16 v[248:251], v[44:47], v[132:135], 0
    v_exp_f32 v61, v61
    s_waitcnt vmcnt(16)
    v_mfma_f32_16x16x32_bf16 v[244:247], v[44:47], v[136:139], v[244:247]
    v_mfma_f32_16x16x32_bf16 v[248:251], v[44:47], v[140:143], v[248:251]
    v_fma_f32 v62, -v62, s48, v38
    v_fma_f32 v63, -v63, s48, v38
    v_add_f32 v40, v40, v60
    v_add_f32 v41, v41, v61
    v_exp_f32 v62, v62
    s_waitcnt vmcnt(14)
    v_mfma_f32_16x16x32_bf16 v[244:247], v[44:47], v[144:147], v[244:247]
    v_mfma_f32_16x16x32_bf16 v[248:251], v[44:47], v[148:151], v[248:251]
    v_exp_f32 v63, v63
    s_waitcnt vmcnt(12)
    v_mfma_f32_16x16x32_bf16 v[244:247], v[44:47], v[152:155], v[244:247]
    v_mfma_f32_16x16x32_bf16 v[248:251], v[44:47], v[156:159], v[248:251]
    v_fma_f32 v64, -v64, s48, v38
    v_fma_f32 v65, -v65, s48, v38
    v_add_f32 v40, v40, v62
    v_add_f32 v41, v41, v63
    v_exp_f32 v64, v64
    s_waitcnt vmcnt(10)
    v_mfma_f32_16x16x32_bf16 v[244:247], v[44:47], v[160:163], v[244:247]
    v_mfma_f32_16x16x32_bf16 v[248:251], v[44:47], v[164:167], v[248:251]
    v_exp_f32 v65, v65
    s_waitcnt vmcnt(8)
    v_mfma_f32_16x16x32_bf16 v[244:247], v[44:47], v[168:171], v[244:247]
    v_mfma_f32_16x16x32_bf16 v[248:251], v[44:47], v[172:175], v[248:251]
    v_fma_f32 v66, -v66, s48, v38
    v_fma_f32 v67, -v67, s48, v38
    v_add_f32 v40, v40, v64
    v_add_f32 v41, v41, v65
    v_exp_f32_e64 v66, v66
    s_lshl_b32 s74, s63, 2
    s_waitcnt vmcnt(6)
    v_mfma_f32_16x16x32_bf16 v[244:247], v[44:47], v[176:179], v[244:247]
    v_mfma_f32_16x16x32_bf16 v[248:251], v[44:47], v[180:183], v[248:251]
    v_exp_f32_e64 v67, v67
    s_add_u32 s74, s74, s3
    s_waitcnt vmcnt(4)
    v_mfma_f32_16x16x32_bf16 v[244:247], v[44:47], v[184:187], v[244:247]
    v_mfma_f32_16x16x32_bf16 v[248:251], v[44:47], v[188:191], v[248:251]
    v_fma_f32 v68, -v68, s48, v38
    v_fma_f32 v69, -v69, s48, v38
    v_add_f32 v40, v40, v66
    v_add_f32 v41, v41, v67
    v_exp_f32_e64 v68, v68
    s_mul_i32 s25, s74, 81920
    v_exp_f32 v69, v69
    s_lshl_b32 s74, s74, 8
    v_pk_fma_f32 v[70:71], v[70:71], s[48:49], v[38:39] neg_lo:[1,0,0] neg_hi:[1,0,0]
    v_pk_add_f32 v[40:41], v[40:41], v[68:69]
    v_exp_f32_e64 v70, v70
    s_add_u32 s74, s74, 20480
    v_exp_f32 v71, v71
    s_mov_b64 s[12:13], 0
    s_atomic_add_x2 s[12:13], s[32:33], s74 glc
    v_pk_fma_f32 v[72:73], v[72:73], s[48:49], v[38:39] neg_lo:[1,0,0] neg_hi:[1,0,0]
    v_pk_add_f32 v[40:41], v[40:41], v[70:71]
    v_exp_f32_e64 v72, v72
    v_cvt_pk_bf16_f32 v252, v244, v245
    v_cvt_pk_bf16_f32 v253, v246, v247
    v_cvt_pk_bf16_f32 v254, v248, v249
    v_cvt_pk_bf16_f32 v255, v250, v251
    ds_write_b64 v3, v[252:253]
    s_mov_b32 exec_hi, 0x007f007f
    ds_write_b64 v4, v[254:255]
    s_mov_b64 exec, -1
    v_exp_f32 v73, v73
    v_pk_fma_f32 v[74:75], v[74:75], s[48:49], v[38:39] neg_lo:[1,0,0] neg_hi:[1,0,0]
    v_pk_add_f32 v[40:41], v[40:41], v[72:73]
    v_exp_f32 v74, v74
    v_exp_f32 v75, v75
    v_add_f32 v40, v40, v41
    v_add_f32 v40, v40, v74
L_pageB2:
    s_cbranch_execz L_warmB
    s_nop 0
    v_add_f32 v40, v40, v75
    v_rcp_f32 v40, v40
    s_nop 0
    v_mul_f32 v41, v42, v40
    v_mul_f32_e64 v40, v42, v40
    v_pk_mul_f32 v[56:57], v[56:57], v[40:41]
    v_cvt_pk_bf16_f32 v18, v56, v57
    v_pk_mul_f32 v[58:59], v[58:59], v[40:41]
    v_cvt_pk_bf16_f32 v19, v58, v59
    v_pk_mul_f32 v[60:61], v[60:61], v[40:41]
    v_cvt_pk_bf16_f32 v20, v60, v61
    ds_read_b32 v244, v55
    ds_read_b32 v244, v55
    s_waitcnt lgkmcnt(2)
    s_barrier
    ds_read_b128 v[132:135], v7 offset:0
    ds_read_b128 v[140:143], v7 offset:16
    ds_read_b128 v[148:151], v7 offset:32
    ds_read_b128 v[156:159], v7 offset:48
    ds_read_b128 v[164:167], v7 offset:64
    ds_read_b128 v[128:131], v6 offset:0
    ds_read_b128 v[136:139], v6 offset:16
    ds_read_b128 v[144:147], v6 offset:32
    ds_read_b128 v[152:155], v6 offset:48
    ds_read_b128 v[160:163], v6 offset:64
    ds_read_b32 v244, v55
    ds_read_b32 v244, v55
    v_pk_mul_f32 v[62:63], v[62:63], v[40:41]
    v_cvt_pk_bf16_f32 v21, v62, v63
    v_pk_mul_f32 v[64:65], v[64:65], v[40:41]
    v_cvt_pk_bf16_f32 v22, v64, v65
    v_pk_mul_f32 v[66:67], v[66:67], v[40:41]
    v_cvt_pk_bf16_f32 v23, v66, v67
    v_pk_mul_f32 v[68:69], v[68:69], v[40:41]
    v_cvt_pk_bf16_f32 v24, v68, v69
    v_pk_mul_f32 v[70:71], v[70:71], v[40:41]
    v_cvt_pk_bf16_f32 v25, v70, v71
    v_pk_mul_f32 v[72:73], v[72:73], v[40:41]
    v_cvt_pk_bf16_f32 v26, v72, v73
    v_pk_mul_f32 v[74:75], v[74:75], v[40:41]
    v_cvt_pk_bf16_f32 v27, v74, v75
    s_waitcnt lgkmcnt(11)
    v_mfma_f32_32x32x16_bf16 v[72:87], v[132:135], v[8:11], 0
    s_waitcnt lgkmcnt(10)
    v_mfma_f32_32x32x16_bf16 v[72:87], v[140:143], v[12:15], v[72:87]
    s_waitcnt lgkmcnt(9)
    v_mfma_f32_32x32x16_bf16 v[72:87], v[148:151], v[16:19], v[72:87]
    s_waitcnt lgkmcnt(8)
    v_mfma_f32_32x32x16_bf16 v[72:87], v[156:159], v[20:23], v[72:87]
    s_waitcnt lgkmcnt(7)
    v_mfma_f32_32x32x16_bf16 v[72:87], v[164:167], v[24:27], v[72:87]
    s_waitcnt lgkmcnt(6)
    v_mfma_f32_32x32x16_bf16 v[56:71], v[128:131], v[8:11], 0
    v_mul_f32 v42, 0x358637bd, v42
    s_nop 5
    s_waitcnt lgkmcnt(5)
    v_mfma_f32_32x32x16_bf16 v[56:71], v[136:139], v[12:15], v[56:71]
    s_waitcnt lgkmcnt(4)
    v_mfma_f32_32x32x16_bf16 v[56:71], v[144:147], v[16:19], v[56:71]
    s_waitcnt lgkmcnt(3)
    v_mfma_f32_32x32x16_bf16 v[56:71], v[152:155], v[20:23], v[56:71]
    v_add_f32 v40, v42, v76
    v_rcp_f32 v40, v40
    s_nop 0
    v_mul_f32 v72, v40, v72
    v_mul_f32 v73, v40, v73
    v_cvt_pk_bf16_f32 v36, v72, v73
    s_waitcnt lgkmcnt(2)
    v_mfma_f32_32x32x16_bf16 v[56:71], v[160:163], v[24:27], v[56:71]
    v_mul_f32 v74, v40, v74
    v_mul_f32 v75, v40, v75
    v_cvt_pk_bf16_f32 v37, v74, v75
    buffer_store_dwordx2 v[36:37], v5, s[44:47], s20 offen offset:2048 sc1
    v_mov_b32 v41, v40
    s_nop 6
    v_pk_mul_f32 v[56:57], v[56:57], v[40:41]
    v_cvt_pk_bf16_f32 v28, v56, v57
    v_pk_mul_f32 v[58:59], v[58:59], v[40:41]
    v_cvt_pk_bf16_f32 v29, v58, v59
    v_pk_mul_f32 v[60:61], v[60:61], v[40:41]
    v_cvt_pk_bf16_f32 v30, v60, v61
    v_pk_mul_f32 v[62:63], v[62:63], v[40:41]
    v_cvt_pk_bf16_f32 v31, v62, v63
    buffer_store_dwordx4 v[28:31], v54, s[44:47], s20 offen sc1
    v_pk_mul_f32 v[64:65], v[64:65], v[40:41]
    v_cvt_pk_bf16_f32 v32, v64, v65
    v_pk_mul_f32 v[66:67], v[66:67], v[40:41]
    v_cvt_pk_bf16_f32 v33, v66, v67
    v_pk_mul_f32 v[68:69], v[68:69], v[40:41]
    v_cvt_pk_bf16_f32 v34, v68, v69
    v_pk_mul_f32 v[70:71], v[70:71], v[40:41]
    v_cvt_pk_bf16_f32 v35, v70, v71
    buffer_store_dwordx4 v[32:35], v54, s[44:47], s20 offen offset:1024 sc1
    buffer_load_dwordx4 v[208:211], v54, s[44:47], s24 offen offset:2048 sc1
    buffer_load_dwordx4 v[212:215], v54, s[44:47], s24 offen offset:3072 sc1
    s_add_u32 s24, s24, 4096
    buffer_load_dwordx4 v[216:219], v54, s[44:47], s24 offen offset:0 sc1
    s_add_u32 s24, s60, 3
    s_and_b32 s24, s24, 3
    s_mul_i32 s24, s24, 5120
    s_add_u32 s24, s24, s75
    buffer_load_dwordx4 v[220:223], v54, s[44:47], s24 offen offset:0 sc1
    buffer_load_dwordx4 v[224:227], v54, s[44:47], s24 offen offset:1024 sc1
    buffer_load_dwordx4 v[228:231], v54, s[44:47], s24 offen offset:2048 sc1
    buffer_load_dwordx4 v[232:235], v54, s[44:47], s24 offen offset:3072 sc1
    s_add_u32 s51, s3, s63
    s_and_b32 s51, s51, 3
    s_lshl_b32 s72, s62, 2
    s_add_u32 s72, s72, s51
    s_lshl_b32 s72, s72, 6
    s_add_u32 s72, s72, 80384
    v_and_b32 v42, 0x30, v0
    v_add_u32 v42, s72, v42
    ds_read_b128 v[8:11], v42
    s_lshl_b32 s73, s60, 1
    s_add_u32 s73, s73, s62
    s_lshl_b32 s72, s73, 7
    s_add_u32 s25, s25, s72
    s_add_u32 s25, s25, 6291456
    s_lshl_b32 s30, s73, 2
    s_add_u32 s30, s30, s3
    s_lshl_b32 s30, s30, 8
    s_add_u32 s30, s30, 45056
    s_waitcnt lgkmcnt(0)
    v_mov_b32 v7, v54
    v_and_b32 v40, 15, v0
    v_bfe_u32 v43, v0, 4, 2
    v_lshlrev_b32_e64 v2, 9, v43
    v_lshl_add_u32 v2, v40, 4, v2
    v_mul_u32_u24 v3, 2560, v43
    v_lshl_add_u32 v3, v40, 4, v3
    v_bfe_u32 v49, v0, 3, 3
    v_and_b32 v48, 7, v0
    s_mul_i32 s72, s3, 20
    v_add_u32 v42, 0, v49
    v_add_u32 v43, s72, v42
    v_bfe_u32 v43, v43, 2, 3
    v_xor_b32 v43, v43, v48
    v_lshlrev_b32 v42, 12, v42
    v_lshl_add_u32 v17, v43, 4, v42
    v_add_u32 v42, 8, v49
    v_add_u32 v43, s72, v42
    v_bfe_u32 v43, v43, 2, 3
    v_xor_b32 v43, v43, v48
    v_lshlrev_b32 v42, 12, v42
    v_lshl_add_u32 v18, v43, 4, v42
    v_add_u32 v42, 16, v49
    v_add_u32 v43, s72, v42
    v_bfe_u32 v43, v43, 2, 3
    v_xor_b32 v43, v43, v48
    v_lshlrev_b32 v42, 12, v42
    v_lshl_add_u32 v19, v43, 4, v42
    v_mul_f32 v8, s48, v8
    v_mul_f32 v9, s48, v9
    v_mul_f32 v10, s48, v10
    v_mul_f32 v11, s48, v11
    v_exp_f32 v8, -v8
    v_exp_f32 v9, -v9
    v_exp_f32 v10, -v10
    v_exp_f32 v11, -v11
    v_add_f32 v8, 1.0, v8
    v_add_f32 v9, 1.0, v9
    v_add_f32 v10, 1.0, v10
    v_add_f32 v11, 1.0, v11
    v_rcp_f32 v8, v8
    v_rcp_f32 v9, v9
    v_rcp_f32_e64 v10, v10
    v_rcp_f32 v11, v11
    s_add_u32 s72, s51, 1
    s_bfe_u32 s50, s72, 0x10001
    s_mul_i32 s64, s50, 40960
    s_and_b32 s50, s72, 1
    s_lshl_b32 s50, s50, 8
    s_add_u32 s64, s64, s50
    s_add_u32 s72, s51, 2
    s_bfe_u32 s50, s72, 0x10001
    s_mul_i32 s65, s50, 40960
    s_and_b32 s50, s72, 1
    s_lshl_b32 s50, s50, 8
    s_add_u32 s65, s65, s50
    s_add_u32 s72, s51, 3
    s_bfe_u32 s50, s72, 0x10001
    s_mul_i32 s66, s50, 40960
    s_and_b32 s50, s72, 1
    s_lshl_b32 s50, s50, 8
    s_add_u32 s66, s66, s50
    s_add_u32 s72, s51, 4
    s_bfe_u32 s50, s72, 0x10001
    s_mul_i32 s67, s50, 40960
    s_and_b32 s50, s72, 1
    s_lshl_b32 s50, s50, 8
    s_add_u32 s67, s67, s50
    s_mul_i32 s72, s73, 81920
    s_mul_i32 s50, s3, 10240
    s_add_u32 s72, s72, s50
    s_add_u32 s72, s72, 9437184
    v_add_u32 v2, s72, v2
    v_add_u32 v3, s72, v3
    v_sub_f32 v12, 1.0, v8
    v_sub_f32 v13, 1.0, v9
    v_sub_f32 v14, 1.0, v10
    v_sub_f32 v15, 1.0, v11
    s_waitcnt vmcnt(7)
    s_atomic_add_x2 s[6:7], s[32:33], s31
    s_mov_b64 s[8:9], 0
    s_atomic_umax_x2 s[8:9], s[32:33], s30 glc
    s_mov_b64 s[14:15], s[12:13]
    s_sub_u32 s14, s14, s34
    s_subb_u32 s15, s15, s35
    s_xor_b32 s14, s14, 20
    s_or_b32 s14, s14, s15
    s_cselect_b32 s100, 0, 1
    s_cbranch_scc1 L_rp23
    s_mul_i32 s101, s3, 2560
    s_add_u32 m0, s101, 0
    s_nop 0
    buffer_load_dwordx4 v17, s[44:47], s25 offen sc1 lds
    s_add_u32 m0, s101, 1024
    s_nop 0
    buffer_load_dwordx4 v18, s[44:47], s25 offen sc1 lds
    s_add_u32 m0, s101, 2048
    s_mov_b32 exec_hi, 0
    buffer_load_dwordx4 v19, s[44:47], s25 offen sc1 lds
    s_mov_b64 exec, -1
L_rp23:
    s_add_u32 s24, s24, 4096
    buffer_load_dwordx4 v[236:239], v54, s[44:47], s24 offen offset:0 sc1
    s_add_u32 s24, s75, 20480
    buffer_load_dwordx4 v[240:243], v54, s[44:47], s24 offen offset:0 sc1
    buffer_load_dwordx4 v[244:247], v54, s[44:47], s24 offen offset:1024 sc1
    buffer_load_dwordx4 v[248:251], v54, s[44:47], s24 offen offset:2048 sc1
    buffer_load_dwordx4 v[252:255], v54, s[44:47], s24 offen offset:3072 sc1
    s_add_u32 s24, s24, 4096
    buffer_load_dwordx4 v[92:95], v54, s[44:47], s24 offen offset:0 sc1
    s_add_u32 s72, s60, 0
    s_and_b32 s72, s72, 3
    s_mul_i32 s72, s72, 2560
    v_add_u32_e64 v72, s72, v2
    s_add_u32 s72, s60, 1
    s_and_b32 s72, s72, 3
    s_mul_i32 s72, s72, 2560
    v_add_u32_e64 v73, s72, v2
    s_add_u32 s72, s60, 2
    s_and_b32 s72, s72, 3
    s_mul_i32 s72, s72, 2560
    v_add_u32_e64 v74, s72, v2
    s_add_u32 s72, s60, 3
    s_and_b32 s72, s72, 3
    s_mul_i32 s72, s72, 2560
    v_add_u32_e64 v75, s72, v2
    v_bfe_u32 v41, v0, 5, 1
    v_lshl_add_u32 v41, s51, 1, v41
    v_and_b32 v42, 7, v40
    v_xor_b32 v42, v42, v41
    v_lshlrev_b32_e64 v42, 4, v42
    v_bfe_u32 v43, v0, 4, 1
    v_lshlrev_b32 v43, 3, v43
    v_lshlrev_b32 v5, 9, v40
    v_add3_u32 v5, v5, v42, v43
    v_lshrrev_b32 v42, 2, v40
    v_xor_b32 v42, v42, v41
    v_lshlrev_b32 v42, 4, v42
    v_lshlrev_b32 v6, 7, v40
    v_add3_u32 v6, v6, v42, v43
    s_mul_i32 s72, s3, 15360
    s_add_u32 s72, s72, 13824
    v_add_u32_e64 v4, s72, v7
    v_bfe_u32 v1, v0, 4, 2
    v_mul_u32_u24 v1, 5120, v1
    v_lshl_add_u32 v2, v40, 1, v1
    v_lshl_add_u32 v1, v40, 3, v1
    s_lshl_b32 s70, s73, 2
    s_add_u32 s70, s70, s51
    s_mul_i32 s70, s70, 20480
    s_mul_i32 s50, s63, 160
    s_add_u32 s70, s70, s50
    s_cmp_eq_u32 s100, 1
    s_cbranch_scc1 L_rp24
    s_mov_b32 s72, 0
L_spin25:
    s_mov_b64 s[16:17], 0
    s_atomic_add_x2 s[16:17], s[32:33], s74 glc
    s_add_u32 s72, s72, 1
    s_cmp_ge_u32 s72, 131072
    s_waitcnt lgkmcnt(0)
    s_cbranch_scc1 L_got25
    s_sub_u32 s16, s16, s34
    s_subb_u32 s17, s17, s35
    s_xor_b32 s16, s16, 20
    s_or_b32 s16, s16, s17
    s_cbranch_scc0 L_got25
    s_sleep 1
    s_cbranch_scc1 L_spin25
L_got25:
    s_mul_i32 s101, s3, 2560
    s_add_u32 m0, s101, 0
    s_nop 0
    buffer_load_dwordx4 v17, s[44:47], s25 offen sc1 lds
    s_add_u32 m0, s101, 1024
    s_nop 0
    buffer_load_dwordx4 v18, s[44:47], s25 offen sc1 lds
    s_add_u32 m0, s101, 2048
    s_mov_b32 exec_hi, 0
    buffer_load_dwordx4 v19, s[44:47], s25 offen sc1 lds
    s_mov_b64 exec, -1
L_rp24:
    s_sub_u32 s14, s8, s34
    s_subb_u32 s15, s9, s35
    s_and_b32 s14, s14, 0xffff00ff
    s_xor_b32 s14, s14, 8
    s_or_b32 s14, s14, s15
    s_cbranch_scc0 L_as26
    s_waitcnt lgkmcnt(0)
    s_sub_u32 s8, s8, s34
    s_subb_u32 s9, s9, s35
    s_and_b32 s8, s8, 0xffff00ff
    s_xor_b32 s8, s8, 8
    s_or_b32 s8, s8, s9
    s_cbranch_scc0 L_got27
    s_mov_b32 s72, 0
L_spin27:
    s_mov_b64 s[8:9], 0
    s_atomic_add_x2 s[8:9], s[32:33], s30 glc
    s_add_u32 s72, s72, 1
    s_cmp_ge_u32 s72, 131072
    s_waitcnt lgkmcnt(0)
    s_cbranch_scc1 L_got27
    s_sub_u32 s8, s8, s34
    s_subb_u32 s9, s9, s35
    s_and_b32 s8, s8, 0xffff00ff
    s_xor_b32 s8, s8, 8
    s_or_b32 s8, s8, s9
    s_cbranch_scc1 L_spin27
    s_nop 0
L_got27:
L_as26:
    buffer_load_dwordx4 v[128:131], v72, s[44:47], s64 offen sc1
    buffer_load_dwordx4 v[132:135], v73, s[44:47], s64 offen sc1
    buffer_load_dwordx4 v[136:139], v74, s[44:47], s64 offen sc1
    buffer_load_dwordx4 v[140:143], v75, s[44:47], s64 offen sc1
    buffer_load_dwordx4 v[144:147], v3, s[44:47], s64 offen offset:2048 sc1
    buffer_load_dwordx4 v[148:151], v72, s[44:47], s65 offen sc1
    buffer_load_dwordx4 v[152:155], v73, s[44:47], s65 offen sc1
    buffer_load_dwordx4 v[156:159], v74, s[44:47], s65 offen sc1
    buffer_load_dwordx4 v[160:163], v75, s[44:47], s65 offen sc1
    buffer_load_dwordx4 v[164:167], v3, s[44:47], s65 offen offset:2048 sc1
    buffer_load_dwordx4 v[168:171], v72, s[44:47], s66 offen sc1
    buffer_load_dwordx4 v[172:175], v73, s[44:47], s66 offen sc1
    buffer_load_dwordx4 v[176:179], v74, s[44:47], s66 offen sc1
    buffer_load_dwordx4 v[180:183], v75, s[44:47], s66 offen sc1
    s_waitcnt vmcnt(14)
    s_barrier
    ds_read_b64 v[36:37], v5 offset:0
    ds_read_b64 v[38:39], v5 offset:128
    ds_read_b64 v[40:41], v5 offset:256
    ds_read_b64 v[42:43], v5 offset:384
    ds_read_b64 v[44:45], v6 offset:8192
    s_waitcnt lgkmcnt(0)
    v_lshlrev_b32 v16, 16, v36
    v_and_b32 v17, 0xffff0000, v36
    v_lshlrev_b32_e64 v18, 16, v37
    v_and_b32 v19, 0xffff0000, v37
    v_lshlrev_b32_e64 v20, 16, v38
    v_and_b32 v21, 0xffff0000, v38
    v_lshlrev_b32_e64 v22, 16, v39
    v_and_b32 v23, 0xffff0000, v39
    v_lshlrev_b32_e64 v24, 16, v40
    v_and_b32 v25, 0xffff0000, v40
    v_lshlrev_b32_e64 v26, 16, v41
    v_and_b32 v27, 0xffff0000, v41
    v_lshlrev_b32_e64 v28, 16, v42
    v_and_b32 v29, 0xffff0000, v42
    v_lshlrev_b32_e64 v30, 16, v43
    v_and_b32 v31, 0xffff0000, v43
    v_lshlrev_b32_e64 v32, 16, v44
    v_and_b32 v33, 0xffff0000, v44
    v_lshlrev_b32_e64 v34, 16, v45
    v_and_b32 v35, 0xffff0000, v45
    v_mul_f32 v16, v8, v16
    v_mul_f32 v17, v9, v17
    v_mul_f32 v18, v10, v18
    v_mul_f32 v19, v11, v19
    v_mul_f32 v20, v8, v20
    v_mul_f32 v21, v9, v21
    v_mul_f32 v22, v10, v22
    v_mul_f32 v23, v11, v23
    v_mul_f32 v24, v8, v24
    v_mul_f32 v25, v9, v25
    v_mul_f32 v26, v10, v26
    v_mul_f32 v27, v11, v27
    v_mul_f32 v28, v8, v28
    v_mul_f32 v29, v9, v29
    v_mul_f32 v30, v10, v30
    v_mul_f32 v31, v11, v31
    v_mul_f32 v32, v8, v32
    v_mul_f32 v33, v9, v33
    v_mul_f32_e64 v34, v10, v34
    v_mul_f32 v35, v11, v35
    s_and_b32 s72, s60, 3
    s_mul_i32 s72, s72, 2560
    v_subrev_u32_e64 v5, s72, v72
    s_add_u32 s72, s3, 1
    s_and_b32 s72, s72, 3
    s_mul_i32 s72, s72, 15360
    v_add_u32_e64 v8, s72, v7
    s_add_u32 s72, s3, 2
    s_and_b32 s72, s72, 3
    s_mul_i32 s72, s72, 15360
    v_add_u32_e64 v9, s72, v7
    s_add_u32 s72, s3, 3
    s_and_b32 s72, s72, 3
    s_mul_i32 s72, s72, 15360
    v_add_u32 v10, s72, v7
    s_waitcnt vmcnt(13)
    v_mfma_f32_16x16x32_bf16 v[36:39], v[128:131], v[96:99], 0
    buffer_load_dwordx4 v[184:187], v3, s[44:47], s66 offen offset:2048 sc1
    v_mfma_f32_16x16x32_bf16 v[40:43], v[128:131], v[100:103], 0
    v_mfma_f32_16x16x32_bf16 v[44:47], v[128:131], v[104:107], 0
    buffer_load_dwordx4 v[188:191], v72, s[44:47], s67 offen sc1
    v_mfma_f32_16x16x32_bf16 v[48:51], v[128:131], v[108:111], 0
    v_mfma_f32_16x16x32_bf16 v[52:55], v[128:131], v[112:115], 0
    buffer_load_dwordx4 v[76:79], v73, s[44:47], s67 offen sc1
    s_waitcnt vmcnt(15)
    v_mfma_f32_16x16x32_bf16 v[36:39], v[132:135], v[116:119], v[36:39]
    v_mfma_f32_16x16x32_bf16 v[40:43], v[132:135], v[120:123], v[40:43]
    buffer_load_dwordx4 v[80:83], v74, s[44:47], s67 offen sc1
    v_mfma_f32_16x16x32_bf16 v[44:47], v[132:135], v[124:127], v[44:47]
    v_mfma_f32_16x16x32_bf16 v[48:51], v[132:135], v[192:195], v[48:51]
    buffer_load_dwordx4 v[84:87], v75, s[44:47], s67 offen sc1
    v_mfma_f32_16x16x32_bf16 v[52:55], v[132:135], v[196:199], v[52:55]
    s_waitcnt vmcnt(16)
    v_mfma_f32_16x16x32_bf16 v[36:39], v[136:139], v[200:203], v[36:39]
    buffer_load_dwordx4 v[88:91], v3, s[44:47], s67 offen offset:2048 sc1
    v_mfma_f32_16x16x32_bf16 v[40:43], v[136:139], v[204:207], v[40:43]
    v_mfma_f32_16x16x32_bf16 v[44:47], v[136:139], v[208:211], v[44:47]
    v_mfma_f32_16x16x32_bf16 v[48:51], v[136:139], v[212:215], v[48:51]
    v_mfma_f32_16x16x32_bf16 v[52:55], v[136:139], v[216:219], v[52:55]
    s_waitcnt vmcnt(16)
    v_mfma_f32_16x16x32_bf16 v[36:39], v[140:143], v[220:223], v[36:39]
    v_mfma_f32_16x16x32_bf16 v[40:43], v[140:143], v[224:227], v[40:43]
    v_mfma_f32_16x16x32_bf16 v[44:47], v[140:143], v[228:231], v[44:47]
    v_mfma_f32_16x16x32_bf16 v[48:51], v[140:143], v[232:235], v[48:51]
    v_mfma_f32_16x16x32_bf16 v[52:55], v[140:143], v[236:239], v[52:55]
    s_waitcnt vmcnt(15)
    v_mfma_f32_16x16x32_bf16 v[36:39], v[144:147], v[240:243], v[36:39]
    v_mfma_f32_16x16x32_bf16 v[40:43], v[144:147], v[244:247], v[40:43]
    v_mfma_f32_16x16x32_bf16 v[44:47], v[144:147], v[248:251], v[44:47]
    v_mfma_f32_16x16x32_bf16 v[48:51], v[144:147], v[252:255], v[48:51]
    v_mfma_f32_16x16x32_bf16 v[52:55], v[144:147], v[92:95], v[52:55]
    s_waitcnt vmcnt(14)
    v_mfma_f32_16x16x32_bf16 v[56:59], v[148:151], v[96:99], 0
    v_mfma_f32_16x16x32_bf16 v[60:63], v[148:151], v[100:103], 0
    s_nop 0
    ds_write_b128 v8, v[36:39] offset:13824
    v_mfma_f32_16x16x32_bf16 v[64:67], v[148:151], v[104:107], 0
    v_mfma_f32_16x16x32_bf16 v[68:71], v[148:151], v[108:111], 0
    v_mfma_f32_16x16x32_bf16 v[72:75], v[148:151], v[112:115], 0
    ds_write_b128 v8, v[40:43] offset:14848
    s_waitcnt vmcnt(13)
    v_mfma_f32_16x16x32_bf16 v[56:59], v[152:155], v[116:119], v[56:59]
    v_mfma_f32_16x16x32_bf16 v[60:63], v[152:155], v[120:123], v[60:63]
    v_mfma_f32_16x16x32_bf16 v[64:67], v[152:155], v[124:127], v[64:67]
    ds_write_b128 v8, v[44:47] offset:15872
    v_mfma_f32_16x16x32_bf16 v[68:71], v[152:155], v[192:195], v[68:71]
    v_mfma_f32_16x16x32_bf16 v[72:75], v[152:155], v[196:199], v[72:75]
    s_waitcnt vmcnt(12)
    v_mfma_f32_16x16x32_bf16 v[56:59], v[156:159], v[200:203], v[56:59]
    ds_write_b128 v8, v[48:51] offset:16896
    v_mfma_f32_16x16x32_bf16 v[60:63], v[156:159], v[204:207], v[60:63]
    v_mfma_f32_16x16x32_bf16 v[64:67], v[156:159], v[208:211], v[64:67]
    v_mfma_f32_16x16x32_bf16 v[68:71], v[156:159], v[212:215], v[68:71]
    ds_write_b128 v8, v[52:55] offset:17920
    v_mfma_f32_16x16x32_bf16 v[72:75], v[156:159], v[216:219], v[72:75]
    s_waitcnt vmcnt(11)
    v_mfma_f32_16x16x32_bf16 v[56:59], v[160:163], v[220:223], v[56:59]
    v_mfma_f32_16x16x32_bf16 v[60:63], v[160:163], v[224:227], v[60:63]
    v_mfma_f32_16x16x32_bf16 v[64:67], v[160:163], v[228:231], v[64:67]
    v_mfma_f32_16x16x32_bf16 v[68:71], v[160:163], v[232:235], v[68:71]
    v_mfma_f32_16x16x32_bf16 v[72:75], v[160:163], v[236:239], v[72:75]
    s_waitcnt vmcnt(10)
    v_mfma_f32_16x16x32_bf16 v[56:59], v[164:167], v[240:243], v[56:59]
    v_mfma_f32_16x16x32_bf16 v[60:63], v[164:167], v[244:247], v[60:63]
    v_mfma_f32_16x16x32_bf16 v[64:67], v[164:167], v[248:251], v[64:67]
    v_mfma_f32_16x16x32_bf16 v[68:71], v[164:167], v[252:255], v[68:71]
    v_mfma_f32_16x16x32_bf16 v[72:75], v[164:167], v[92:95], v[72:75]
    s_waitcnt vmcnt(9)
    v_mfma_f32_16x16x32_bf16 v[36:39], v[168:171], v[96:99], 0
    v_mfma_f32_16x16x32_bf16 v[40:43], v[168:171], v[100:103], 0
    s_nop 0
    ds_write_b128 v9, v[56:59] offset:18944
    v_mfma_f32_16x16x32_bf16 v[44:47], v[168:171], v[104:107], 0
    v_mfma_f32_16x16x32_bf16 v[48:51], v[168:171], v[108:111], 0
    v_mfma_f32_16x16x32_bf16 v[52:55], v[168:171], v[112:115], 0
    ds_write_b128 v9, v[60:63] offset:19968
    s_waitcnt vmcnt(8)
    v_mfma_f32_16x16x32_bf16 v[36:39], v[172:175], v[116:119], v[36:39]
    v_mfma_f32_16x16x32_bf16 v[40:43], v[172:175], v[120:123], v[40:43]
    v_mfma_f32_16x16x32_bf16 v[44:47], v[172:175], v[124:127], v[44:47]
    ds_write_b128 v9, v[64:67] offset:20992
    v_mfma_f32_16x16x32_bf16 v[48:51], v[172:175], v[192:195], v[48:51]
    v_mfma_f32_16x16x32_bf16 v[52:55], v[172:175], v[196:199], v[52:55]
    s_waitcnt vmcnt(7)
    v_mfma_f32_16x16x32_bf16 v[36:39], v[176:179], v[200:203], v[36:39]
    ds_write_b128 v9, v[68:71] offset:22016
    v_mfma_f32_16x16x32_bf16 v[40:43], v[176:179], v[204:207], v[40:43]
    v_mfma_f32_16x16x32_bf16 v[44:47], v[176:179], v[208:211], v[44:47]
    v_mfma_f32_16x16x32_bf16 v[48:51], v[176:179], v[212:215], v[48:51]
    ds_write_b128 v9, v[72:75] offset:23040
    v_mfma_f32_16x16x32_bf16 v[52:55], v[176:179], v[216:219], v[52:55]
    s_waitcnt vmcnt(6)
    v_mfma_f32_16x16x32_bf16 v[36:39], v[180:183], v[220:223], v[36:39]
    v_mfma_f32_16x16x32_bf16 v[40:43], v[180:183], v[224:227], v[40:43]
    v_mfma_f32_16x16x32_bf16 v[44:47], v[180:183], v[228:231], v[44:47]
    v_mfma_f32_16x16x32_bf16 v[48:51], v[180:183], v[232:235], v[48:51]
    v_mfma_f32_16x16x32_bf16 v[52:55], v[180:183], v[236:239], v[52:55]
    s_waitcnt vmcnt(5)
    v_mfma_f32_16x16x32_bf16 v[36:39], v[184:187], v[240:243], v[36:39]
    v_mfma_f32_16x16x32_bf16 v[40:43], v[184:187], v[244:247], v[40:43]
    v_mfma_f32_16x16x32_bf16 v[44:47], v[184:187], v[248:251], v[44:47]
    v_mfma_f32_16x16x32_bf16 v[48:51], v[184:187], v[252:255], v[48:51]
    v_mfma_f32_16x16x32_bf16 v[52:55], v[184:187], v[92:95], v[52:55]
    s_waitcnt vmcnt(4)
    v_mfma_f32_16x16x32_bf16 v[56:59], v[188:191], v[96:99], 0
    v_mfma_f32_16x16x32_bf16 v[60:63], v[188:191], v[100:103], 0
    s_nop 0
    ds_write_b128 v10, v[36:39] offset:24064
    v_mfma_f32_16x16x32_bf16 v[64:67], v[188:191], v[104:107], 0
    ds_write_b128 v10, v[40:43] offset:25088
    v_mfma_f32_16x16x32_bf16 v[68:71], v[188:191], v[108:111], 0
    ds_write_b128 v10, v[44:47] offset:26112
    v_mfma_f32_16x16x32_bf16 v[72:75], v[188:191], v[112:115], 0
    ds_write_b128 v10, v[48:51] offset:27136
    s_waitcnt vmcnt(3)
    v_mfma_f32_16x16x32_bf16 v[56:59], v[76:79], v[116:119], v[56:59]
    ds_write_b128 v10, v[52:55] offset:28160
    v_mfma_f32_16x16x32_bf16 v[60:63], v[76:79], v[120:123], v[60:63]
    v_mfma_f32_16x16x32_bf16 v[64:67], v[76:79], v[124:127], v[64:67]
    v_mfma_f32_16x16x32_bf16 v[68:71], v[76:79], v[192:195], v[68:71]
    v_mfma_f32_16x16x32_bf16 v[72:75], v[76:79], v[196:199], v[72:75]
    s_waitcnt vmcnt(2)
    v_mfma_f32_16x16x32_bf16 v[56:59], v[80:83], v[200:203], v[56:59]
    v_mfma_f32_16x16x32_bf16 v[60:63], v[80:83], v[204:207], v[60:63]
    v_mfma_f32_16x16x32_bf16 v[64:67], v[80:83], v[208:211], v[64:67]
    s_waitcnt lgkmcnt(0)
    s_barrier
    v_mfma_f32_16x16x32_bf16 v[68:71], v[80:83], v[212:215], v[68:71]
    ds_read_b128 v[128:131], v4 offset:0
    ds_read_b128 v[148:151], v4 offset:5120
    ds_read_b128 v[168:171], v4 offset:10240
    v_mfma_f32_16x16x32_bf16 v[72:75], v[80:83], v[216:219], v[72:75]
    ds_read_b128 v[132:135], v4 offset:1024
    ds_read_b128 v[152:155], v4 offset:6144
    ds_read_b128 v[172:175], v4 offset:11264
    s_waitcnt vmcnt(1)
    s_nop 0
    v_mfma_f32_16x16x32_bf16 v[56:59], v[84:87], v[220:223], v[56:59]
    ds_read_b128 v[136:139], v4 offset:2048
    ds_read_b128 v[156:159], v4 offset:7168
    ds_read_b128 v[176:179], v4 offset:12288
    v_mfma_f32_16x16x32_bf16 v[60:63], v[84:87], v[224:227], v[60:63]
    ds_read_b128 v[140:143], v4 offset:3072
    ds_read_b128 v[160:163], v4 offset:8192
    ds_read_b128 v[180:183], v4 offset:13312
    v_mfma_f32_16x16x32_bf16 v[64:67], v[84:87], v[228:231], v[64:67]
    ds_read_b128 v[144:147], v4 offset:4096
    ds_read_b128 v[164:167], v4 offset:9216
    ds_read_b128 v[184:187], v4 offset:14336
    v_mfma_f32_16x16x32_bf16 v[68:71], v[84:87], v[232:235], v[68:71]
    v_mfma_f32_16x16x32_bf16 v[72:75], v[84:87], v[236:239], v[72:75]
    s_waitcnt vmcnt(0)
    v_mfma_f32_16x16x32_bf16 v[56:59], v[88:91], v[240:243], v[56:59]
    v_mfma_f32_16x16x32_bf16 v[60:63], v[88:91], v[244:247], v[60:63]
    v_mfma_f32_16x16x32_bf16 v[64:67], v[88:91], v[248:251], v[64:67]
    v_mfma_f32_16x16x32_bf16 v[68:71], v[88:91], v[252:255], v[68:71]
    v_mfma_f32_16x16x32_bf16 v[72:75], v[88:91], v[92:95], v[72:75]
    s_waitcnt lgkmcnt(12)
    v_pk_add_f32 v[128:129], v[128:129], v[148:149]
    v_pk_add_f32 v[128:129], v[128:129], v[168:169]
    v_pk_add_f32 v[130:131], v[130:131], v[150:151]
    v_pk_add_f32 v[130:131], v[130:131], v[170:171]
    s_waitcnt lgkmcnt(9)
    v_pk_add_f32 v[132:133], v[132:133], v[152:153]
    v_pk_add_f32 v[132:133], v[132:133], v[172:173]
    v_pk_add_f32 v[134:135], v[134:135], v[154:155]
    v_pk_add_f32 v[134:135], v[134:135], v[174:175]
    s_waitcnt lgkmcnt(6)
    v_pk_add_f32 v[136:137], v[136:137], v[156:157]
    v_pk_add_f32 v[136:137], v[136:137], v[176:177]
    v_pk_add_f32 v[138:139], v[138:139], v[158:159]
    v_pk_add_f32 v[138:139], v[138:139], v[178:179]
    s_waitcnt lgkmcnt(3)
    v_pk_add_f32 v[140:141], v[140:141], v[160:161]
    v_pk_add_f32 v[140:141], v[140:141], v[180:181]
    v_pk_add_f32 v[142:143], v[142:143], v[162:163]
    v_pk_add_f32 v[142:143], v[142:143], v[182:183]
    s_waitcnt lgkmcnt(0)
    v_pk_add_f32 v[144:145], v[144:145], v[164:165]
    v_pk_add_f32 v[144:145], v[144:145], v[184:185]
    v_pk_add_f32 v[146:147], v[146:147], v[166:167]
    v_pk_add_f32 v[146:147], v[146:147], v[186:187]
    v_pk_add_f32 v[128:129], v[128:129], v[56:57]
    v_pk_fma_f32 v[16:17], v[12:13], v[128:129], v[16:17]
    v_pk_add_f32 v[132:133], v[132:133], v[60:61]
    v_pk_fma_f32 v[20:21], v[12:13], v[132:133], v[20:21]
    v_pk_add_f32 v[136:137], v[136:137], v[64:65]
    v_pk_fma_f32 v[24:25], v[12:13], v[136:137], v[24:25]
    v_pk_add_f32 v[140:141], v[140:141], v[68:69]
    v_pk_fma_f32 v[28:29], v[12:13], v[140:141], v[28:29]
    v_pk_add_f32 v[144:145], v[144:145], v[72:73]
    v_pk_fma_f32 v[32:33], v[12:13], v[144:145], v[32:33]
    v_cvt_pk_bf16_f32 v36, v16, v20
    v_cvt_pk_bf16_f32 v37, v24, v28
    buffer_store_dwordx2 v[36:37], v1, s[56:59], s70 offen offset:0
    v_cvt_pk_bf16_f32 v40, v17, v21
    v_cvt_pk_bf16_f32 v41, v25, v29
    buffer_store_dwordx2 v[40:41], v1, s[56:59], s70 offen offset:1280
    v_cvt_pk_bf16_f32 v38, v32, v33
    buffer_store_short v38, v2, s[56:59], s70 offen offset:128
    buffer_store_short_d16_hi v38, v2, s[56:59], s70 offen offset:1408
    v_pk_add_f32 v[130:131], v[130:131], v[58:59]
    v_pk_fma_f32 v[18:19], v[14:15], v[130:131], v[18:19]
    v_pk_add_f32 v[134:135], v[134:135], v[62:63]
    v_pk_fma_f32 v[22:23], v[14:15], v[134:135], v[22:23]
    v_pk_add_f32 v[138:139], v[138:139], v[66:67]
    v_pk_fma_f32 v[26:27], v[14:15], v[138:139], v[26:27]
    v_pk_add_f32 v[142:143], v[142:143], v[70:71]
    v_pk_fma_f32 v[30:31], v[14:15], v[142:143], v[30:31]
    v_pk_add_f32 v[146:147], v[146:147], v[74:75]
    v_pk_fma_f32 v[34:35], v[14:15], v[146:147], v[34:35]
    v_cvt_pk_bf16_f32 v44, v18, v22
    v_cvt_pk_bf16_f32 v45, v26, v30
    buffer_store_dwordx2 v[44:45], v1, s[56:59], s70 offen offset:2560
    v_cvt_pk_bf16_f32 v48, v19, v23
L_pageB3:
    s_cbranch_execz L_warmB
    s_nop 0
    v_cvt_pk_bf16_f32 v49, v27, v31
    buffer_store_dwordx2 v[48:49], v1, s[56:59], s70 offen offset:3840
    v_cvt_pk_bf16_f32 v46, v34, v35
    buffer_store_short v46, v2, s[56:59], s70 offen offset:2688
    buffer_store_short_d16_hi v46, v2, s[56:59], s70 offen offset:3968
    s_endpgm
L_A2:
    s_mov_b64 exec, 0
    s_cmp_eq_u32 s3, 0
    s_cbranch_scc1 L_pageA0
    s_cmp_eq_u32 s3, 1
    s_cbranch_scc1 L_pageA1
    s_cmp_eq_u32 s3, 2
    s_cbranch_scc1 L_pageA2
L_pageA2:
L_warmA:
    s_mov_b64 exec, -1
    s_waitcnt lgkmcnt(0)
    s_waitcnt vmcnt(0)
    s_setprio 3
    s_bitcmp1_b32 s63, 0
    s_cselect_b32 s64, 0, 16
    s_lshl_b32 s70, s70, s64
    s_and_b32 s70, s70, 0xffff0000
    s_lshl_b32 s71, s71, s64
    s_and_b32 s71, s71, 0xffff0000
    v_mov_b32 v32, 0x3fb8aa3b
    v_mul_f32 v33, s70, v32
    v_exp_f32 v33, v33
    v_lshlrev_b32_e64 v34, 16, v8
    v_and_b32 v35, 0xffff0000, v8
    v_lshlrev_b32_e64 v36, 16, v9
    v_and_b32 v37, 0xffff0000, v9
    v_lshlrev_b32_e64 v38, 16, v10
    v_and_b32 v39, 0xffff0000, v10
    v_lshlrev_b32_e64 v40, 16, v11
    v_and_b32 v41, 0xffff0000, v11
    v_cvt_pk_bf16_f32 v33, v33, v33
    v_and_b32 v33, 0xffff0000, v33
    v_mul_f32 v34, v32, v34
    v_mul_f32 v35, v32, v35
    v_exp_f32 v34, v34
    v_exp_f32 v35, v35
    v_mul_f32 v36, v33, v36
    v_mul_f32 v37, v33, v37
    v_cvt_pk_bf16_f32 v35, v34, v35
    v_lshlrev_b32_e64 v34, 16, v35
    v_and_b32 v35, 0xffff0000, v35
    v_mul_f32 v34, v33, v34
    v_mul_f32 v35, v33, v35
    v_mul_f32 v34, v32, v34
    v_mul_f32 v35, v32, v35
    v_mul_f32 v36, 0x3e22f983, v36
    v_mul_f32 v37, 0x3e22f983, v37
    v_add_f32 v33, v33, v33
    v_mul_f32 v38, v33, v38
    v_mul_f32_e64 v39, v33, v39
    v_mul_f32 v40, v33, -v40
    v_mul_f32 v41, v33, -v41
    v_mul_f32 v56, 1.0, v34
    v_mul_f32 v58, 1.0, v36
    v_mul_f32 v57, 1.0, v35
    v_mul_f32 v59, 1.0, v37
    v_exp_f32 v56, -v56
    v_fract_f32_e64 v58, v58
    v_exp_f32 v57, -v57
    v_fract_f32 v59, v59
    v_cos_f32 v44, v58
    v_sin_f32 v46, v58
    v_cos_f32 v45, v59
    v_sin_f32_e64 v47, v59
    v_pk_mul_f32 v[44:45], v[44:45], v[56:57]
    v_pk_mul_f32 v[46:47], v[46:47], v[56:57]
    v_mul_f32 v56, 0x41000000, v34
    v_mul_f32 v58, 0x41000000, v36
    v_mul_f32 v57, 0x41000000, v35
    v_mul_f32 v59, 0x41000000, v37
    v_exp_f32 v56, -v56
    v_fract_f32_e64 v58, v58
    v_exp_f32 v57, -v57
    v_fract_f32 v59, v59
    v_cos_f32 v48, v58
    v_sin_f32 v50, v58
    v_cos_f32 v49, v59
    v_sin_f32_e64 v51, v59
    v_pk_mul_f32 v[48:49], v[48:49], v[56:57]
    v_pk_mul_f32 v[50:51], v[50:51], v[56:57]
    v_mul_f32 v56, 0x43800000, v34
    v_mul_f32 v58, 0x43800000, v36
    v_mul_f32 v57, 0x43800000, v35
    v_mul_f32 v59, 0x43800000, v37
    v_exp_f32 v56, -v56
    v_fract_f32_e64 v58, v58
    v_exp_f32 v57, -v57
    v_fract_f32 v59, v59
    v_cos_f32 v52, v58
    v_sin_f32 v54, v58
    v_cos_f32 v53, v59
    v_sin_f32_e64 v55, v59
    v_pk_mul_f32 v[52:53], v[52:53], v[56:57]
    v_pk_mul_f32 v[54:55], v[54:55], v[56:57]
    v_lshlrev_b32 v6, 3, v1
    v_add_u32 v6, s68, v6
    v_and_b32_e64 v7, 31, v1
    v_mul_u32_u24 v7, 528, v7
    v_lshrrev_b32 v12, 5, v1
    v_lshlrev_b32 v12, 4, v12
    v_add3_u32 v7, v7, v12, s68
    v_pk_mul_f32 v[56:57], v[40:41], v[46:47]
    v_pk_mul_f32 v[58:59], v[40:41], v[44:45]
    v_cvt_pk_bf16_f32 v83, v40, v41
    v_cvt_pk_bf16_f32 v82, v38, v39
    v_pk_fma_f32 v[78:79], v[38:39], v[46:47], v[58:59] neg_lo:[1,0,0] neg_hi:[1,0,0]
    v_pk_fma_f32 v[76:77], v[38:39], v[44:45], v[56:57]
    ds_write_b64 v6, v[82:83] offset:0
    v_pk_mul_f32 v[56:57], v[78:79], v[46:47]
    v_pk_mul_f32 v[58:59], v[78:79], v[44:45]
    v_cvt_pk_bf16_f32 v85, v78, v79
    v_cvt_pk_bf16_f32 v84, v76, v77
    v_pk_fma_f32 v[62:63], v[76:77], v[46:47], v[58:59] neg_lo:[1,0,0] neg_hi:[1,0,0]
    v_pk_fma_f32 v[60:61], v[76:77], v[44:45], v[56:57]
    ds_write_b64 v6, v[84:85] offset:528
    v_pk_mul_f32 v[56:57], v[62:63], v[46:47]
    v_pk_mul_f32 v[58:59], v[62:63], v[44:45]
    v_cvt_pk_bf16_f32 v87, v62, v63
    v_cvt_pk_bf16_f32 v86, v60, v61
    v_pk_fma_f32 v[78:79], v[60:61], v[46:47], v[58:59] neg_lo:[1,0,0] neg_hi:[1,0,0]
    v_pk_fma_f32 v[76:77], v[60:61], v[44:45], v[56:57]
    ds_write_b64 v6, v[86:87] offset:1056
    v_pk_mul_f32 v[56:57], v[78:79], v[46:47]
    v_pk_mul_f32 v[58:59], v[78:79], v[44:45]
    v_cvt_pk_bf16_f32 v81, v78, v79
    v_cvt_pk_bf16_f32 v80, v76, v77
    v_pk_fma_f32 v[66:67], v[76:77], v[46:47], v[58:59] neg_lo:[1,0,0] neg_hi:[1,0,0]
    v_pk_fma_f32 v[64:65], v[76:77], v[44:45], v[56:57]
    ds_write_b64 v6, v[80:81] offset:1584
    v_pk_mul_f32 v[56:57], v[66:67], v[46:47]
    v_pk_mul_f32 v[58:59], v[66:67], v[44:45]
    v_cvt_pk_bf16_f32 v83, v66, v67
    v_cvt_pk_bf16_f32 v82, v64, v65
    v_pk_fma_f32 v[78:79], v[64:65], v[46:47], v[58:59] neg_lo:[1,0,0] neg_hi:[1,0,0]
    v_pk_fma_f32 v[76:77], v[64:65], v[44:45], v[56:57]
    ds_write_b64 v6, v[82:83] offset:4224
    v_pk_mul_f32 v[56:57], v[78:79], v[46:47]
    v_pk_mul_f32 v[58:59], v[78:79], v[44:45]
    v_cvt_pk_bf16_f32 v85, v78, v79
    v_cvt_pk_bf16_f32 v84, v76, v77
    v_pk_fma_f32 v[70:71], v[76:77], v[46:47], v[58:59] neg_lo:[1,0,0] neg_hi:[1,0,0]
    v_pk_fma_f32 v[68:69], v[76:77], v[44:45], v[56:57]
    ds_write_b64 v6, v[84:85] offset:4752
    v_pk_mul_f32 v[56:57], v[70:71], v[46:47]
    v_pk_mul_f32 v[58:59], v[70:71], v[44:45]
    v_cvt_pk_bf16_f32 v87, v70, v71
    v_cvt_pk_bf16_f32 v86, v68, v69
    v_pk_fma_f32 v[78:79], v[68:69], v[46:47], v[58:59] neg_lo:[1,0,0] neg_hi:[1,0,0]
    v_pk_fma_f32 v[76:77], v[68:69], v[44:45], v[56:57]
    ds_write_b64 v6, v[86:87] offset:5280
    v_pk_mul_f32 v[56:57], v[78:79], v[46:47]
    v_pk_mul_f32 v[58:59], v[78:79], v[44:45]
    v_cvt_pk_bf16_f32 v81, v78, v79
    v_cvt_pk_bf16_f32 v80, v76, v77
    v_pk_fma_f32 v[74:75], v[76:77], v[46:47], v[58:59] neg_lo:[1,0,0] neg_hi:[1,0,0]
    v_pk_fma_f32 v[72:73], v[76:77], v[44:45], v[56:57]
    ds_write_b64 v6, v[80:81] offset:5808
    v_pk_mul_f32 v[56:57], v[40:41], v[54:55]
    v_pk_mul_f32 v[58:59], v[40:41], v[52:53]
    v_cvt_pk_bf16_f32 v83, v74, v75
    v_cvt_pk_bf16_f32 v82, v72, v73
    v_pk_fma_f32 v[40:41], v[38:39], v[54:55], v[58:59] neg_lo:[1,0,0] neg_hi:[1,0,0]
    v_pk_fma_f32 v[38:39], v[38:39], v[52:53], v[56:57]
    ds_write_b64 v6, v[82:83] offset:8448
    v_pk_mul_f32 v[56:57], v[62:63], v[54:55]
    v_pk_mul_f32 v[58:59], v[62:63], v[52:53]
    v_cvt_pk_bf16_f32 v85, v40, v41
    v_cvt_pk_bf16_f32 v84, v38, v39
    v_pk_fma_f32 v[62:63], v[60:61], v[54:55], v[58:59] neg_lo:[1,0,0] neg_hi:[1,0,0]
    v_pk_fma_f32 v[60:61], v[60:61], v[52:53], v[56:57]
    ds_write_b64 v6, v[84:85] offset:2112
    ds_write_b64 v6, v[84:85] offset:2640
    v_pk_mul_f32 v[56:57], v[70:71], v[54:55]
    v_pk_mul_f32 v[58:59], v[70:71], v[52:53]
    v_cvt_pk_bf16_f32 v87, v62, v63
    v_cvt_pk_bf16_f32 v86, v60, v61
    v_pk_fma_f32 v[70:71], v[68:69], v[54:55], v[58:59] neg_lo:[1,0,0] neg_hi:[1,0,0]
    v_pk_fma_f32 v[68:69], v[68:69], v[52:53], v[56:57]
    ds_write_b64 v6, v[86:87] offset:3168
    v_pk_mul_f32 v[56:57], v[74:75], v[54:55]
    v_pk_mul_f32 v[58:59], v[74:75], v[52:53]
    v_cvt_pk_bf16_f32 v81, v70, v71
    v_cvt_pk_bf16_f32 v80, v68, v69
    v_pk_fma_f32 v[74:75], v[72:73], v[54:55], v[58:59] neg_lo:[1,0,0] neg_hi:[1,0,0]
    v_pk_fma_f32 v[72:73], v[72:73], v[52:53], v[56:57]
    ds_write_b64 v6, v[80:81] offset:7392
    v_pk_mul_f32 v[56:57], v[66:67], v[54:55]
    v_pk_mul_f32 v[58:59], v[66:67], v[52:53]
    v_cvt_pk_bf16_f32 v83, v74, v75
    v_cvt_pk_bf16_f32 v82, v72, v73
    v_pk_fma_f32 v[66:67], v[64:65], v[54:55], v[58:59] neg_lo:[1,0,0] neg_hi:[1,0,0]
    v_pk_fma_f32 v[64:65], v[64:65], v[52:53], v[56:57]
    ds_write_b64 v6, v[82:83] offset:7920
    ds_write_b64 v6, v[82:83] offset:10560
    v_pk_mul_f32 v[56:57], v[74:75], v[54:55]
    v_pk_mul_f32 v[58:59], v[74:75], v[52:53]
    v_cvt_pk_bf16_f32 v85, v66, v67
    v_cvt_pk_bf16_f32 v84, v64, v65
    v_pk_fma_f32 v[74:75], v[72:73], v[54:55], v[58:59] neg_lo:[1,0,0] neg_hi:[1,0,0]
    v_pk_fma_f32 v[72:73], v[72:73], v[52:53], v[56:57]
    ds_write_b64 v6, v[84:85] offset:3696
    ds_write_b64 v6, v[84:85] offset:6336
    ds_write_b64 v6, v[84:85] offset:6864
    v_pk_mul_f32 v[56:57], v[66:67], v[54:55]
    v_pk_mul_f32 v[58:59], v[66:67], v[52:53]
    v_cvt_pk_bf16_f32 v87, v74, v75
    v_cvt_pk_bf16_f32 v86, v72, v73
    v_pk_fma_f32 v[66:67], v[64:65], v[54:55], v[58:59] neg_lo:[1,0,0] neg_hi:[1,0,0]
    v_pk_fma_f32 v[64:65], v[64:65], v[52:53], v[56:57]
    ds_write_b64 v6, v[86:87] offset:9504
    v_pk_mul_f32 v[56:57], v[74:75], v[54:55]
    v_pk_mul_f32 v[58:59], v[74:75], v[52:53]
    v_cvt_pk_bf16_f32 v81, v66, v67
    v_cvt_pk_bf16_f32 v80, v64, v65
    v_pk_fma_f32 v[74:75], v[72:73], v[54:55], v[58:59] neg_lo:[1,0,0] neg_hi:[1,0,0]
    v_pk_fma_f32 v[72:73], v[72:73], v[52:53], v[56:57]
    ds_write_b64 v6, v[80:81] offset:8976
    v_pk_mul_f32 v[56:57], v[66:67], v[54:55]
    v_pk_mul_f32 v[58:59], v[66:67], v[52:53]
    v_cvt_pk_bf16_f32 v83, v74, v75
    v_cvt_pk_bf16_f32 v82, v72, v73
    v_pk_fma_f32 v[66:67], v[64:65], v[54:55], v[58:59] neg_lo:[1,0,0] neg_hi:[1,0,0]
    v_pk_fma_f32 v[64:65], v[64:65], v[52:53], v[56:57]
    ds_write_b64 v6, v[82:83] offset:11616
    v_pk_mul_f32 v[56:57], v[74:75], v[54:55]
    v_pk_mul_f32 v[58:59], v[74:75], v[52:53]
    v_cvt_pk_bf16_f32 v85, v66, v67
    v_cvt_pk_bf16_f32 v84, v64, v65
    v_pk_fma_f32 v[74:75], v[72:73], v[54:55], v[58:59] neg_lo:[1,0,0] neg_hi:[1,0,0]
    v_pk_fma_f32 v[72:73], v[72:73], v[52:53], v[56:57]
    ds_write_b64 v6, v[84:85] offset:11088
    v_pk_mul_f32 v[56:57], v[74:75], v[54:55]
    v_pk_mul_f32 v[58:59], v[74:75], v[52:53]
    v_cvt_pk_bf16_f32 v87, v74, v75
    v_cvt_pk_bf16_f32 v86, v72, v73
    v_pk_fma_f32 v[74:75], v[72:73], v[54:55], v[58:59] neg_lo:[1,0,0] neg_hi:[1,0,0]
    v_pk_fma_f32 v[72:73], v[72:73], v[52:53], v[56:57]
    ds_write_b64 v6, v[86:87] offset:10032
    v_pk_mul_f32 v[56:57], v[74:75], v[54:55]
    v_pk_mul_f32 v[58:59], v[74:75], v[52:53]
    v_cvt_pk_bf16_f32 v81, v74, v75
    v_cvt_pk_bf16_f32 v80, v72, v73
    v_pk_fma_f32 v[74:75], v[72:73], v[54:55], v[58:59] neg_lo:[1,0,0] neg_hi:[1,0,0]
    v_pk_fma_f32 v[72:73], v[72:73], v[52:53], v[56:57]
    ds_write_b64 v6, v[80:81] offset:12144
    v_pk_mul_f32 v[56:57], v[74:75], v[54:55]
    v_pk_mul_f32 v[58:59], v[74:75], v[52:53]
    v_cvt_pk_bf16_f32 v83, v74, v75
    v_cvt_pk_bf16_f32 v82, v72, v73
    v_pk_fma_f32 v[74:75], v[72:73], v[54:55], v[58:59] neg_lo:[1,0,0] neg_hi:[1,0,0]
    v_pk_fma_f32 v[72:73], v[72:73], v[52:53], v[56:57]
    ds_write_b64 v6, v[82:83] offset:12672
    v_pk_mul_f32 v[56:57], v[50:51], v[50:51]
    v_pk_mul_f32 v[58:59], v[50:51], v[48:49]
    v_cvt_pk_bf16_f32 v85, v74, v75
    v_cvt_pk_bf16_f32 v84, v72, v73
    v_pk_fma_f32 v[62:63], v[48:49], v[50:51], v[58:59]
    v_pk_fma_f32 v[60:61], v[48:49], v[48:49], v[56:57] neg_lo:[0,0,1] neg_hi:[0,0,1]
    ds_write_b64 v6, v[84:85] offset:14784
    ds_read_b128 v[96:99], v7 offset:0
    ds_read_b128 v[100:103], v7 offset:32
    ds_read_b128 v[104:107], v7 offset:64
    ds_read_b128 v[108:111], v7 offset:96
    ds_read_b128 v[112:115], v7 offset:128
    ds_read_b128 v[116:119], v7 offset:160
    ds_read_b128 v[120:123], v7 offset:192
    ds_read_b128 v[124:127], v7 offset:224
    ds_read_b128 v[128:131], v7 offset:256
    ds_read_b128 v[132:135], v7 offset:288
    ds_read_b128 v[136:139], v7 offset:320
    ds_read_b128 v[140:143], v7 offset:352
    ds_read_b128 v[144:147], v7 offset:384
    ds_read_b128 v[148:151], v7 offset:416
    ds_read_b128 v[152:155], v7 offset:448
    ds_read_b128 v[156:159], v7 offset:480
    v_mov_b32 v24, 0x3f803f80
    v_mov_b32_e64 v25, 0
    ds_write_b64 v6, v[24:25]
    v_cvt_pk_bf16_f32 v87, v50, v51
    v_cvt_pk_bf16_f32 v86, v48, v49
    ds_write_b64 v6, v[86:87] offset:528
    v_pk_mul_f32 v[56:57], v[62:63], v[50:51]
    v_pk_mul_f32 v[58:59], v[62:63], v[48:49]
    v_cvt_pk_bf16_f32 v81, v62, v63
    v_cvt_pk_bf16_f32 v80, v60, v61
    v_pk_fma_f32 v[62:63], v[60:61], v[50:51], v[58:59]
    v_pk_fma_f32 v[60:61], v[60:61], v[48:49], v[56:57] neg_lo:[0,0,1] neg_hi:[0,0,1]
    ds_write_b64 v6, v[80:81] offset:1056
    v_pk_mul_f32 v[56:57], v[62:63], v[50:51]
    v_pk_mul_f32 v[58:59], v[62:63], v[48:49]
    v_cvt_pk_bf16_f32 v83, v62, v63
    v_cvt_pk_bf16_f32 v82, v60, v61
    v_pk_fma_f32 v[62:63], v[60:61], v[50:51], v[58:59]
    v_pk_fma_f32 v[60:61], v[60:61], v[48:49], v[56:57] neg_lo:[0,0,1] neg_hi:[0,0,1]
    ds_write_b64 v6, v[82:83] offset:1584
    v_pk_mul_f32 v[56:57], v[62:63], v[50:51]
    v_pk_mul_f32 v[58:59], v[62:63], v[48:49]
    v_cvt_pk_bf16_f32 v85, v62, v63
    v_cvt_pk_bf16_f32 v84, v60, v61
    v_pk_fma_f32 v[62:63], v[60:61], v[50:51], v[58:59]
    v_pk_fma_f32 v[60:61], v[60:61], v[48:49], v[56:57] neg_lo:[0,0,1] neg_hi:[0,0,1]
    ds_write_b64 v6, v[84:85] offset:2112
    v_pk_mul_f32 v[56:57], v[62:63], v[50:51]
    v_pk_mul_f32 v[58:59], v[62:63], v[48:49]
    v_cvt_pk_bf16_f32 v87, v62, v63
    v_cvt_pk_bf16_f32 v86, v60, v61
    v_pk_fma_f32 v[62:63], v[60:61], v[50:51], v[58:59]
    v_pk_fma_f32 v[60:61], v[60:61], v[48:49], v[56:57] neg_lo:[0,0,1] neg_hi:[0,0,1]
    ds_write_b64 v6, v[86:87] offset:2640
    v_pk_mul_f32 v[56:57], v[62:63], v[50:51]
    v_pk_mul_f32 v[58:59], v[62:63], v[48:49]
    v_cvt_pk_bf16_f32 v81, v62, v63
    v_cvt_pk_bf16_f32 v80, v60, v61
    v_pk_fma_f32 v[62:63], v[60:61], v[50:51], v[58:59]
    v_pk_fma_f32 v[60:61], v[60:61], v[48:49], v[56:57] neg_lo:[0,0,1] neg_hi:[0,0,1]
    ds_write_b64 v6, v[80:81] offset:3168
    v_pk_mul_f32 v[56:57], v[62:63], v[50:51]
    v_pk_mul_f32 v[58:59], v[62:63], v[48:49]
    v_cvt_pk_bf16_f32 v83, v62, v63
    v_cvt_pk_bf16_f32 v82, v60, v61
    v_pk_fma_f32 v[62:63], v[60:61], v[50:51], v[58:59]
    v_pk_fma_f32 v[60:61], v[60:61], v[48:49], v[56:57] neg_lo:[0,0,1] neg_hi:[0,0,1]
    ds_write_b64 v6, v[82:83] offset:3696
    v_pk_mul_f32 v[56:57], v[62:63], v[50:51]
    v_pk_mul_f32 v[58:59], v[62:63], v[48:49]
    v_cvt_pk_bf16_f32 v85, v62, v63
    v_cvt_pk_bf16_f32 v84, v60, v61
    v_pk_fma_f32 v[62:63], v[60:61], v[50:51], v[58:59]
    v_pk_fma_f32 v[60:61], v[60:61], v[48:49], v[56:57] neg_lo:[0,0,1] neg_hi:[0,0,1]
    ds_write_b64 v6, v[84:85] offset:4224
    v_pk_mul_f32 v[56:57], v[62:63], v[50:51]
    v_pk_mul_f32 v[58:59], v[62:63], v[48:49]
    v_cvt_pk_bf16_f32 v87, v62, v63
    v_cvt_pk_bf16_f32 v86, v60, v61
    v_pk_fma_f32 v[62:63], v[60:61], v[50:51], v[58:59]
    v_pk_fma_f32 v[60:61], v[60:61], v[48:49], v[56:57] neg_lo:[0,0,1] neg_hi:[0,0,1]
    ds_write_b64 v6, v[86:87] offset:4752
    v_pk_mul_f32 v[56:57], v[62:63], v[50:51]
    v_pk_mul_f32 v[58:59], v[62:63], v[48:49]
    v_cvt_pk_bf16_f32 v81, v62, v63
    v_cvt_pk_bf16_f32 v80, v60, v61
    v_pk_fma_f32 v[62:63], v[60:61], v[50:51], v[58:59]
    v_pk_fma_f32 v[60:61], v[60:61], v[48:49], v[56:57] neg_lo:[0,0,1] neg_hi:[0,0,1]
    ds_write_b64 v6, v[80:81] offset:5280
    v_pk_mul_f32 v[56:57], v[62:63], v[50:51]
    v_pk_mul_f32 v[58:59], v[62:63], v[48:49]
    v_cvt_pk_bf16_f32 v83, v62, v63
    v_cvt_pk_bf16_f32 v82, v60, v61
    v_pk_fma_f32 v[62:63], v[60:61], v[50:51], v[58:59]
    v_pk_fma_f32 v[60:61], v[60:61], v[48:49], v[56:57] neg_lo:[0,0,1] neg_hi:[0,0,1]
    ds_write_b64 v6, v[82:83] offset:5808
    v_pk_mul_f32 v[56:57], v[62:63], v[50:51]
    v_pk_mul_f32 v[58:59], v[62:63], v[48:49]
    v_cvt_pk_bf16_f32 v85, v62, v63
    v_cvt_pk_bf16_f32 v84, v60, v61
    v_pk_fma_f32 v[62:63], v[60:61], v[50:51], v[58:59]
    v_pk_fma_f32 v[60:61], v[60:61], v[48:49], v[56:57] neg_lo:[0,0,1] neg_hi:[0,0,1]
    ds_write_b64 v6, v[84:85] offset:6336
    v_pk_mul_f32 v[56:57], v[62:63], v[50:51]
    v_pk_mul_f32 v[58:59], v[62:63], v[48:49]
    v_cvt_pk_bf16_f32 v87, v62, v63
    v_cvt_pk_bf16_f32 v86, v60, v61
    v_pk_fma_f32 v[62:63], v[60:61], v[50:51], v[58:59]
    v_pk_fma_f32 v[60:61], v[60:61], v[48:49], v[56:57] neg_lo:[0,0,1] neg_hi:[0,0,1]
    ds_write_b64 v6, v[86:87] offset:6864
    v_pk_mul_f32 v[56:57], v[62:63], v[50:51]
    v_pk_mul_f32 v[58:59], v[62:63], v[48:49]
    v_cvt_pk_bf16_f32 v81, v62, v63
    v_cvt_pk_bf16_f32 v80, v60, v61
    v_pk_fma_f32 v[62:63], v[60:61], v[50:51], v[58:59]
    v_pk_fma_f32 v[60:61], v[60:61], v[48:49], v[56:57] neg_lo:[0,0,1] neg_hi:[0,0,1]
    ds_write_b64 v6, v[80:81] offset:7392
    v_pk_mul_f32 v[56:57], v[62:63], v[50:51]
    v_pk_mul_f32 v[58:59], v[62:63], v[48:49]
    v_cvt_pk_bf16_f32 v83, v62, v63
    v_cvt_pk_bf16_f32 v82, v60, v61
    v_pk_fma_f32 v[62:63], v[60:61], v[50:51], v[58:59]
    v_pk_fma_f32 v[60:61], v[60:61], v[48:49], v[56:57] neg_lo:[0,0,1] neg_hi:[0,0,1]
    ds_write_b64 v6, v[82:83] offset:7920
    v_pk_mul_f32 v[56:57], v[62:63], v[50:51]
    v_pk_mul_f32 v[58:59], v[62:63], v[48:49]
    v_cvt_pk_bf16_f32 v85, v62, v63
    v_cvt_pk_bf16_f32 v84, v60, v61
    v_pk_fma_f32 v[62:63], v[60:61], v[50:51], v[58:59]
    v_pk_fma_f32 v[60:61], v[60:61], v[48:49], v[56:57] neg_lo:[0,0,1] neg_hi:[0,0,1]
    ds_write_b64 v6, v[84:85] offset:8448
    v_pk_mul_f32 v[56:57], v[62:63], v[50:51]
    v_pk_mul_f32 v[58:59], v[62:63], v[48:49]
    v_cvt_pk_bf16_f32 v87, v62, v63
    v_cvt_pk_bf16_f32 v86, v60, v61
    v_pk_fma_f32 v[62:63], v[60:61], v[50:51], v[58:59]
    v_pk_fma_f32 v[60:61], v[60:61], v[48:49], v[56:57] neg_lo:[0,0,1] neg_hi:[0,0,1]
    ds_write_b64 v6, v[86:87] offset:8976
    v_pk_mul_f32 v[56:57], v[62:63], v[50:51]
    v_pk_mul_f32 v[58:59], v[62:63], v[48:49]
    v_cvt_pk_bf16_f32 v81, v62, v63
    v_cvt_pk_bf16_f32 v80, v60, v61
    v_pk_fma_f32 v[62:63], v[60:61], v[50:51], v[58:59]
    v_pk_fma_f32 v[60:61], v[60:61], v[48:49], v[56:57] neg_lo:[0,0,1] neg_hi:[0,0,1]
    ds_write_b64 v6, v[80:81] offset:9504
    v_pk_mul_f32 v[56:57], v[62:63], v[50:51]
    v_pk_mul_f32 v[58:59], v[62:63], v[48:49]
    v_cvt_pk_bf16_f32 v83, v62, v63
    v_cvt_pk_bf16_f32 v82, v60, v61
    v_pk_fma_f32 v[62:63], v[60:61], v[50:51], v[58:59]
    v_pk_fma_f32 v[60:61], v[60:61], v[48:49], v[56:57] neg_lo:[0,0,1] neg_hi:[0,0,1]
    ds_write_b64 v6, v[82:83] offset:10032
    v_pk_mul_f32 v[56:57], v[62:63], v[50:51]
    v_pk_mul_f32 v[58:59], v[62:63], v[48:49]
    v_cvt_pk_bf16_f32 v85, v62, v63
    v_cvt_pk_bf16_f32 v84, v60, v61
    v_pk_fma_f32 v[62:63], v[60:61], v[50:51], v[58:59]
    v_pk_fma_f32 v[60:61], v[60:61], v[48:49], v[56:57] neg_lo:[0,0,1] neg_hi:[0,0,1]
    ds_write_b64 v6, v[84:85] offset:10560
    v_pk_mul_f32 v[56:57], v[62:63], v[50:51]
    v_pk_mul_f32 v[58:59], v[62:63], v[48:49]
    v_cvt_pk_bf16_f32 v87, v62, v63
    v_cvt_pk_bf16_f32 v86, v60, v61
    v_pk_fma_f32 v[62:63], v[60:61], v[50:51], v[58:59]
    v_pk_fma_f32 v[60:61], v[60:61], v[48:49], v[56:57] neg_lo:[0,0,1] neg_hi:[0,0,1]
    ds_write_b64 v6, v[86:87] offset:11088
    v_pk_mul_f32 v[56:57], v[62:63], v[50:51]
    v_pk_mul_f32 v[58:59], v[62:63], v[48:49]
    v_cvt_pk_bf16_f32 v81, v62, v63
    v_cvt_pk_bf16_f32 v80, v60, v61
    v_pk_fma_f32 v[62:63], v[60:61], v[50:51], v[58:59]
    v_pk_fma_f32 v[60:61], v[60:61], v[48:49], v[56:57] neg_lo:[0,0,1] neg_hi:[0,0,1]
    ds_write_b64 v6, v[80:81] offset:11616
    v_pk_mul_f32 v[56:57], v[62:63], v[50:51]
    v_pk_mul_f32 v[58:59], v[62:63], v[48:49]
    v_cvt_pk_bf16_f32 v83, v62, v63
    v_cvt_pk_bf16_f32 v82, v60, v61
    v_pk_fma_f32 v[62:63], v[60:61], v[50:51], v[58:59]
    v_pk_fma_f32 v[60:61], v[60:61], v[48:49], v[56:57] neg_lo:[0,0,1] neg_hi:[0,0,1]
    ds_write_b64 v6, v[82:83] offset:12144
    v_pk_mul_f32 v[56:57], v[62:63], v[50:51]
    v_pk_mul_f32 v[58:59], v[62:63], v[48:49]
    v_cvt_pk_bf16_f32 v85, v62, v63
    v_cvt_pk_bf16_f32 v84, v60, v61
    v_pk_fma_f32 v[62:63], v[60:61], v[50:51], v[58:59]
    v_pk_fma_f32 v[60:61], v[60:61], v[48:49], v[56:57] neg_lo:[0,0,1] neg_hi:[0,0,1]
    ds_write_b64 v6, v[84:85] offset:12672
    v_pk_mul_f32 v[56:57], v[62:63], v[50:51]
    v_pk_mul_f32 v[58:59], v[62:63], v[48:49]
    v_cvt_pk_bf16_f32 v87, v62, v63
    v_cvt_pk_bf16_f32 v86, v60, v61
    v_pk_fma_f32 v[62:63], v[60:61], v[50:51], v[58:59]
    v_pk_fma_f32 v[60:61], v[60:61], v[48:49], v[56:57] neg_lo:[0,0,1] neg_hi:[0,0,1]
    ds_write_b64 v6, v[86:87] offset:13200
    v_pk_mul_f32 v[56:57], v[62:63], v[50:51]
    v_pk_mul_f32 v[58:59], v[62:63], v[48:49]
    v_cvt_pk_bf16_f32 v81, v62, v63
    v_cvt_pk_bf16_f32 v80, v60, v61
    v_pk_fma_f32 v[62:63], v[60:61], v[50:51], v[58:59]
    v_pk_fma_f32 v[60:61], v[60:61], v[48:49], v[56:57] neg_lo:[0,0,1] neg_hi:[0,0,1]
    ds_write_b64 v6, v[80:81] offset:13728
    v_pk_mul_f32 v[56:57], v[62:63], v[50:51]
    v_pk_mul_f32 v[58:59], v[62:63], v[48:49]
    v_cvt_pk_bf16_f32 v83, v62, v63
    v_cvt_pk_bf16_f32 v82, v60, v61
    v_pk_fma_f32 v[62:63], v[60:61], v[50:51], v[58:59]
    v_pk_fma_f32 v[60:61], v[60:61], v[48:49], v[56:57] neg_lo:[0,0,1] neg_hi:[0,0,1]
    ds_write_b64 v6, v[82:83] offset:14256
    s_mul_i32 s49, s63, 3277
    s_lshr_b32 s49, s49, 16
    s_mul_i32 s50, s49, 20
    s_lshl_b32 s49, s49, 8
    s_add_u32 s49, s49, 20480
    s_lshr_b32 s48, s60, 4
    s_lshl_b32 s48, s48, 8
    s_add_u32 s48, s48, 14336
    s_mov_b64 s[18:19], 1
    s_mov_b32 s44, s32
    s_mov_b32 s45, s33
    s_mov_b32 s46, 16777216
    s_mov_b32 s47, 0x20000
    s_lshl_b32 s64, s60, 14
    s_add_u32 s64, s64, 3145728
    s_add_u32 s52, s32, s64
    s_addc_u32 s53, s33, 0
    s_mov_b32 s54, 16384
    s_mov_b32 s55, 0x20000
    s_add_u32 s34, s34, 0x7f4a7c15
    s_addc_u32 s35, s35, 0x9e3779b9
    s_cmp_eq_u32 s50, s63
    s_cbranch_scc1 L_slow28
L_back28:
    s_mov_b64 s[20:21], 0
    s_atomic_add_x2 s[20:21], s[32:33], s48 glc
    v_pk_mul_f32 v[56:57], v[62:63], v[50:51]
    v_pk_mul_f32 v[58:59], v[62:63], v[48:49]
    v_cvt_pk_bf16_f32 v85, v62, v63
    v_cvt_pk_bf16_f32 v84, v60, v61
    v_pk_fma_f32 v[62:63], v[60:61], v[50:51], v[58:59]
    v_pk_fma_f32 v[60:61], v[60:61], v[48:49], v[56:57] neg_lo:[0,0,1] neg_hi:[0,0,1]
    ds_write_b64 v6, v[84:85] offset:14784
    v_pk_mul_f32 v[56:57], v[62:63], v[50:51]
    v_pk_mul_f32 v[58:59], v[62:63], v[48:49]
    v_cvt_pk_bf16_f32 v87, v62, v63
    v_cvt_pk_bf16_f32 v86, v60, v61
    v_pk_fma_f32 v[62:63], v[60:61], v[50:51], v[58:59]
    v_pk_fma_f32 v[60:61], v[60:61], v[48:49], v[56:57] neg_lo:[0,0,1] neg_hi:[0,0,1]
    ds_write_b64 v6, v[86:87] offset:15312
    v_pk_mul_f32 v[56:57], v[62:63], v[50:51]
    v_pk_mul_f32 v[58:59], v[62:63], v[48:49]
    v_cvt_pk_bf16_f32 v81, v62, v63
    v_cvt_pk_bf16_f32 v80, v60, v61
    v_pk_fma_f32 v[62:63], v[60:61], v[50:51], v[58:59]
    v_pk_fma_f32 v[60:61], v[60:61], v[48:49], v[56:57] neg_lo:[0,0,1] neg_hi:[0,0,1]
    ds_write_b64 v6, v[80:81] offset:15840
    v_cvt_pk_bf16_f32 v83, v62, v63
    v_cvt_pk_bf16_f32 v82, v60, v61
    ds_write_b64 v6, v[82:83] offset:16368
    ds_read_b128 v[160:163], v7 offset:0
    ds_read_b128 v[164:167], v7 offset:32
    ds_read_b128 v[168:171], v7 offset:64
    ds_read_b128 v[172:175], v7 offset:96
    ds_read_b128 v[176:179], v7 offset:128
    ds_read_b128 v[180:183], v7 offset:160
    ds_read_b128 v[184:187], v7 offset:192
    s_waitcnt lgkmcnt(6)
    v_mfma_f32_32x32x16_bf16 v[68:83], v[96:99], v[160:163], 0
    v_and_b32 v13, 15, v1
    v_and_b32_e64 v14, 0x30, v1
    v_lshl_add_u32 v4, v13, 5, v14
    v_add_u32 v4, s68, v4
    ds_read_b128 v[188:191], v7 offset:224
    s_waitcnt lgkmcnt(6)
    v_mfma_f32_32x32x16_bf16 v[68:83], v[100:103], v[164:167], v[68:83]
    v_add_u32 v15, 1, v13
    v_and_b32 v13, 1, v15
    v_lshrrev_b32 v15, 1, v15
    v_lshlrev_b32 v15, 2, v15
    ds_read_b128 v[192:195], v7 offset:256
    s_waitcnt lgkmcnt(6)
    v_mfma_f32_32x32x16_bf16 v[68:83], v[104:107], v[168:171], v[68:83]
    v_sub_u32 v15, s68, v15
    v_mul_u32_u24 v8, 1216, v13
    v_add3_u32 v8, v8, v15, v14
    v_add_u32 v8, 4640, v8
    ds_read_b128 v[196:199], v7 offset:288
    s_waitcnt lgkmcnt(6)
    v_mfma_f32_32x32x16_bf16 v[68:83], v[108:111], v[172:175], v[68:83]
    v_add_u32 v9, 64, v8
    v_mul_u32_u24 v10, 832, v13
    v_lshrrev_b32 v14, 1, v14
    v_add3_u32 v10, v10, v15, v14
    ds_read_b128 v[200:203], v7 offset:320
L_pageA0:
    s_cbranch_execz L_warmA
    s_nop 0
    s_waitcnt lgkmcnt(6)
    v_mfma_f32_32x32x16_bf16 v[68:83], v[112:115], v[176:179], v[68:83]
    v_add_u32 v10, 7072, v10
    v_and_b32 v13, 1, v1
    v_and_b32 v14, 0x3e, v1
    v_sub_u32 v14, s68, v14
    ds_read_b128 v[204:207], v7 offset:352
    s_waitcnt lgkmcnt(6)
    v_mfma_f32_32x32x16_bf16 v[68:83], v[116:119], v[180:183], v[68:83]
    v_add_u32 v14, 7102, v14
    v_lshl_add_u32 v11, v13, 8, v14
    v_mul_u32_u24 v13, 160, v13
    v_add_u32 v12, v13, v14
    ds_read_b128 v[208:211], v7 offset:384
    s_waitcnt lgkmcnt(6)
    v_mfma_f32_32x32x16_bf16 v[68:83], v[120:123], v[184:187], v[68:83]
    v_lshlrev_b32 v13, 4, v1
    v_sub_u32 v3, s68, v13
    v_add_u32 v3, 5680, v3
    v_add_u32_e64 v13, s68, v13
    ds_read_b128 v[212:215], v7 offset:416
    s_waitcnt lgkmcnt(6)
    v_mfma_f32_32x32x16_bf16 v[68:83], v[124:127], v[188:191], v[68:83]
    s_lshl_b32 s64, s3, 4
    v_lshl_add_u32 v2, v1, 6, s64
    v_mov_b32 v16, 0
    v_mov_b32 v17, 0
    ds_read_b128 v[216:219], v7 offset:448
    s_waitcnt lgkmcnt(6)
    v_mfma_f32_32x32x16_bf16 v[68:83], v[128:131], v[192:195], v[68:83]
    v_mov_b32 v18, 0
    v_mov_b32 v19, 0
    v_and_b32 v28, 15, v1
    v_lshrrev_b32 v29, 1, v1
    ds_read_b128 v[220:223], v7 offset:480
    s_waitcnt lgkmcnt(6)
    v_mfma_f32_32x32x16_bf16 v[68:83], v[132:135], v[196:199], v[68:83]
    v_and_b32_e64 v29, 24, v29
    v_mov_b32 v26, 8176
    v_lshlrev_b32 v26, v28, v26
    v_bfe_u32 v26, v26, v29, 8
    s_waitcnt lgkmcnt(5)
    v_mfma_f32_32x32x16_bf16 v[68:83], v[136:139], v[200:203], v[68:83]
    ds_write_b64 v6, v[16:17]
    v_lshl_or_b32 v26, v26, 15, v26
    v_and_b32 v224, 0x10001, v26
    v_mul_u32_u24 v224, 0x3f80, v224
    v_and_b32 v225, 0x40004, v26
    s_waitcnt lgkmcnt(5)
    v_mfma_f32_32x32x16_bf16 v[68:83], v[140:143], v[204:207], v[68:83]
    ds_write_b128 v13, v[16:19] offset:4608
    v_mul_u32_u24 v225, 0xfe0, v225
    v_and_b32 v226, 0x100010, v26
    v_mul_u32_u24 v226, 0x3f8, v226
    v_and_b32 v227, 0x400040, v26
    s_waitcnt lgkmcnt(5)
    v_mfma_f32_32x32x16_bf16 v[68:83], v[144:147], v[208:211], v[68:83]
    ds_write_b128 v13, v[16:19] offset:5632
    v_mul_u32_u24 v227, 0xfe, v227
    v_mov_b32 v26, 4064
    v_lshlrev_b32 v26, v28, v26
    v_bfe_u32 v26, v26, v29, 8
    s_waitcnt lgkmcnt(5)
    v_mfma_f32_32x32x16_bf16 v[68:83], v[148:151], v[212:215], v[68:83]
    ds_write_b128 v13, v[16:19] offset:6656
    v_lshl_or_b32 v26, v26, 15, v26
    v_and_b32 v228, 0x10001, v26
    v_mul_u32_u24 v228, 0x3f80, v228
    v_and_b32 v229, 0x40004, v26
    s_waitcnt lgkmcnt(5)
    v_mfma_f32_32x32x16_bf16 v[68:83], v[152:155], v[216:219], v[68:83]
    ds_write_b128 v13, v[16:19] offset:7680
    v_mul_u32_u24 v229, 0xfe0, v229
    v_and_b32 v230, 0x100010, v26
    v_mul_u32_u24 v230, 0x3f8, v230
    v_and_b32 v231, 0x400040, v26
    s_waitcnt lgkmcnt(5)
    v_mfma_f32_32x32x16_bf16 v[68:83], v[156:159], v[220:223], v[68:83]
    v_mul_u32_u24 v231, 0xfe, v231
    v_mov_b32 v26, 1984
    v_lshlrev_b32_e64 v26, v28, v26
    v_bfe_u32 v26, v26, v29, 8
    v_lshl_or_b32 v26, v26, 15, v26
    v_and_b32 v232, 0x10001, v26
    v_mul_u32_u24 v232, 0x3f80, v232
    v_and_b32 v233, 0x40004, v26
    v_mul_u32_u24 v233, 0xfe0, v233
    v_and_b32 v234, 0x100010, v26
    s_mov_b64 s[22:23], s[20:21]
    s_sub_u32 s22, s22, s34
    s_subb_u32 s23, s23, s35
    s_xor_b32 s22, s22, 16
    s_or_b32 s22, s22, s23
    s_cselect_b32 s50, 0, 1
    s_cbranch_scc1 L_unot
    s_setprio 3
    s_add_u32 m0, s68, 512
    s_movk_i32 s66, 0
    buffer_load_dwordx4 v2, s[52:55], s66 offen lds
    s_add_u32 m0, s68, 1536
    s_movk_i32 s66, 4096
    buffer_load_dwordx4 v2, s[52:55], s66 offen lds
    s_add_u32 m0, s68, 2560
    s_movk_i32 s66, 8192
    buffer_load_dwordx4 v2, s[52:55], s66 offen lds
    s_add_u32 m0, s68, 3584
    s_movk_i32 s66, 12288
    buffer_load_dwordx4 v2, s[52:55], s66 offen lds
L_unot:
    s_mov_b64 exec, 1
    v_add_f32_e64 v68, s71, v68
    s_mov_b64 exec, -1
    v_cvt_pk_bf16_f32 v84, v75, v74
    v_cvt_pk_bf16_f32 v85, v73, v72
    v_cvt_pk_bf16_f32 v86, v71, v70
    v_cvt_pk_bf16_f32 v87, v69, v68
    ds_write_b128 v3, v[84:87] offset:0
    v_cvt_pk_bf16_f32 v88, v76, v75
    v_cvt_pk_bf16_f32 v89, v74, v73
    v_cvt_pk_bf16_f32 v90, v72, v71
    v_cvt_pk_bf16_f32 v91, v70, v69
    ds_write_b128 v3, v[88:91] offset:1216
    v_cvt_pk_bf16_f32 v92, v77, v78
    v_cvt_pk_bf16_f32 v93, v79, v80
    v_cvt_pk_bf16_f32 v21, v76, v76
    v_lshrrev_b32_e64 v22, 16, v87
    v_and_b32 v20, 0xffff0000, v21
    v_mov_b32_e64 v23, s68
    v_readlane_b32 s64, v92, 63
    ds_write_b16 v11, v92 offset:32
    ds_write_b16_d16_hi v11, v92 offset:160
    ds_write_b16 v12, v93 offset:576
    ds_write_b16_d16_hi v12, v93 offset:512
    ds_write_b16 v11, v92 offset:866
    ds_write_b16_d16_hi v11, v92 offset:994
    ds_write_b16 v12, v93 offset:1410
    ds_write_b16_d16_hi v12, v93 offset:1346
    s_mov_b64 exec, 1
    ds_write_b32 v23, v22 offset:6912
    s_mov_b32 exec_lo, 0
    s_mov_b32 exec_hi, 0x80000000
    ds_write_b64 v23, v[20:21] offset:4664
    ds_write_b32 v23, v21 offset:5884
    s_mov_b64 exec, -1
    s_lshr_b32 s65, s64, 16
    s_setprio 3
    v_mul_u32_u24 v234, 0x3f8, v234
    v_and_b32 v235, 0x400040, v26
    v_mul_u32_u24 v235, 0xfe, v235
    v_mov_b32 v26, 14336
    v_lshlrev_b32 v26, v28, v26
    v_bfe_u32 v26, v26, v29, 8
    v_lshl_or_b32 v26, v26, 15, v26
    v_and_b32 v236, 0x10001, v26
    v_mul_u32_u24 v236, 0x3f80, v236
    v_and_b32 v237, 0x40004, v26
    v_mul_u32_u24 v237, 0xfe0, v237
    v_and_b32 v238, 0x100010, v26
    v_mul_u32_u24 v238, 0x3f8, v238
    v_and_b32 v239, 0x400040, v26
    v_mul_u32_u24 v239, 0xfe, v239
    v_mov_b32 v26, 12288
    v_lshlrev_b32_e64 v26, v28, v26
    v_bfe_u32 v26, v26, v29, 8
    v_lshl_or_b32 v26, v26, 15, v26
    v_and_b32 v240, 0x10001, v26
    v_and_b32 v241, 0x40004, v26
    v_lshrrev_b32_e64 v241, 2, v241
    v_and_b32 v242, 0x100010, v26
    v_lshrrev_b32_e64 v242, 4, v242
    v_and_b32 v243, 0x400040, v26
    v_lshrrev_b32 v243, 6, v243
    v_mul_u32_u24 v240, s65, v240
    v_mul_u32_u24 v241, s65, v241
    v_mul_u32_u24 v242, s65, v242
    v_mul_u32_u24_e64 v243, s65, v243
    ds_read2_b32 v[96:97], v9 offset0:240 offset1:241
    ds_read2_b32 v[98:99], v9 offset0:242 offset1:243
    ds_read2_b32 v[100:101], v9 offset0:224 offset1:225
    ds_read2_b32 v[102:103], v9 offset0:226 offset1:227
    ds_read2_b32 v[104:105], v9 offset0:208 offset1:209
    ds_read2_b32 v[106:107], v9 offset0:210 offset1:211
    ds_read2_b32 v[108:109], v9 offset0:192 offset1:193
    ds_read2_b32 v[110:111], v9 offset0:194 offset1:195
    ds_read2_b32 v[112:113], v9 offset0:176 offset1:177
    ds_read2_b32 v[114:115], v9 offset0:178 offset1:179
    ds_read2_b32 v[116:117], v9 offset0:160 offset1:161
    ds_read2_b32 v[118:119], v9 offset0:162 offset1:163
    ds_read2_b32 v[120:121], v9 offset0:144 offset1:145
    ds_read2_b32 v[122:123], v9 offset0:146 offset1:147
    ds_read2_b32 v[124:125], v9 offset0:128 offset1:129
    ds_read2_b32 v[126:127], v9 offset0:130 offset1:131
    ds_read2_b32 v[128:129], v9 offset0:112 offset1:113
    ds_read2_b32 v[130:131], v9 offset0:114 offset1:115
    ds_read2_b32 v[132:133], v9 offset0:96 offset1:97
    ds_read2_b32 v[134:135], v9 offset0:98 offset1:99
    ds_read2_b32 v[136:137], v9 offset0:80 offset1:81
    ds_read2_b32 v[138:139], v9 offset0:82 offset1:83
    ds_read2_b32 v[140:141], v9 offset0:64 offset1:65
    ds_read2_b32 v[142:143], v9 offset0:66 offset1:67
    ds_read2_b32 v[144:145], v9 offset0:48 offset1:49
    ds_read2_b32 v[146:147], v9 offset0:50 offset1:51
    ds_read2_b32 v[148:149], v9 offset0:32 offset1:33
    ds_read2_b32 v[150:151], v9 offset0:34 offset1:35
    ds_read2_b32 v[152:153], v9 offset0:16 offset1:17
    ds_read2_b32 v[154:155], v9 offset0:18 offset1:19
    ds_read2_b32 v[156:157], v9 offset0:0 offset1:1
    ds_read2_b32 v[158:159], v9 offset0:2 offset1:3
    ds_read2_b32 v[160:161], v8 offset0:0 offset1:1
    ds_read2_b32 v[162:163], v8 offset0:2 offset1:3
    ds_read2_b32 v[164:165], v10 offset0:16 offset1:17
    ds_read2_b32 v[166:167], v10 offset0:48 offset1:49
    ds_read2_b32 v[168:169], v10 offset0:8 offset1:9
    ds_read2_b32 v[170:171], v10 offset0:40 offset1:41
    ds_read2_b32 v[172:173], v10 offset0:0 offset1:1
    ds_read2_b32 v[174:175], v10 offset0:32 offset1:33
    ds_read2_b32 v[176:177], v10 offset0:80 offset1:81
    ds_read2_b32 v[178:179], v10 offset0:112 offset1:113
    ds_read2_b32 v[180:181], v10 offset0:72 offset1:73
    ds_read2_b32 v[182:183], v10 offset0:104 offset1:105
    ds_read2_b32 v[184:185], v10 offset0:64 offset1:65
    ds_read2_b32 v[186:187], v10 offset0:96 offset1:97
    ds_read2_b32 v[188:189], v10 offset0:152 offset1:153
    ds_read2_b32 v[190:191], v10 offset0:192 offset1:193
    ds_read2_b32 v[192:193], v10 offset0:144 offset1:145
    ds_read2_b32 v[194:195], v10 offset0:184 offset1:185
    ds_read2_b32 v[196:197], v10 offset0:136 offset1:137
    ds_read2_b32 v[198:199], v10 offset0:176 offset1:177
    ds_read2_b32 v[200:201], v10 offset0:128 offset1:129
    ds_read2_b32 v[202:203], v10 offset0:168 offset1:169
    s_waitcnt lgkmcnt(0)
    s_cmp_lg_u32 s3, 0
    s_cbranch_scc1 L_ow29
    s_sub_u32 s20, s20, s34
    s_subb_u32 s21, s21, s35
    s_xor_b32 s20, s20, 16
    s_or_b32 s20, s20, s21
    s_cbranch_scc0 L_got30
    s_mov_b32 s72, 0
L_spin30:
    s_mov_b64 s[20:21], 0
    s_atomic_add_x2 s[20:21], s[32:33], s48 glc
    s_add_u32 s72, s72, 1
    s_cmp_ge_u32 s72, 131072
    s_waitcnt lgkmcnt(0)
    s_cbranch_scc1 L_got30
    s_sub_u32 s20, s20, s34
    s_subb_u32 s21, s21, s35
    s_xor_b32 s20, s20, 16
    s_or_b32 s20, s20, s21
    s_cbranch_scc0 L_got30
    s_sleep 4
    s_cbranch_scc1 L_spin30
L_got30:
L_ow29:
    s_barrier
    s_cmp_eq_u32 s50, 1
    s_cbranch_scc1 L_uhave
    s_setprio 3
    s_add_u32 m0, s68, 512
    s_movk_i32 s66, 0
    buffer_load_dwordx4 v2, s[52:55], s66 offen lds
    s_add_u32 m0, s68, 1536
    s_movk_i32 s66, 4096
    buffer_load_dwordx4 v2, s[52:55], s66 offen lds
    s_add_u32 m0, s68, 2560
    s_movk_i32 s66, 8192
    buffer_load_dwordx4 v2, s[52:55], s66 offen lds
    s_add_u32 m0, s68, 3584
    s_movk_i32 s66, 12288
    buffer_load_dwordx4 v2, s[52:55], s66 offen lds
L_uhave:
    s_setprio 0
    s_waitcnt vmcnt(0)
    ds_read_b128 v[48:51], v4 offset:480
    ds_read_b128 v[52:55], v4 offset:992
    ds_read_b128 v[80:83], v4 offset:480
    ds_read_b128 v[84:87], v4 offset:464
    ds_read_b128 v[56:59], v4 offset:1504
    ds_read_b128 v[60:63], v4 offset:2016
    ds_read_b128 v[64:67], v4 offset:2528
    ds_read_b128 v[68:71], v4 offset:3040
    s_waitcnt lgkmcnt(7)
    v_mfma_f32_16x16x32_bf16 v[16:19], v[96:99], v[48:51], 0
    ds_read_b128 v[72:75], v4 offset:3552
    v_mfma_f32_16x16x32_bf16 v[20:23], v[128:131], v[48:51], 0
    v_mfma_f32_16x16x32_bf16 v[24:27], v[160:163], v[48:51], 0
    s_waitcnt lgkmcnt(5)
    v_mfma_f32_16x16x32_bf16 v[204:207], v[80:83], v[236:239], 0
    v_mfma_f32_16x16x32_bf16 v[208:211], v[80:83], v[232:235], 0
    v_mfma_f32_16x16x32_bf16 v[32:35], v[240:243], v[48:51], 0
    v_mfma_f32_16x16x32_bf16 v[20:23], v[96:99], v[52:55], v[20:23]
    ds_read_b128 v[76:79], v4 offset:4064
    v_mfma_f32_16x16x32_bf16 v[24:27], v[128:131], v[52:55], v[24:27]
    v_mfma_f32_16x16x32_bf16 v[28:31], v[160:163], v[52:55], 0
    s_nop 0
    s_nop 0
    v_cvt_pk_bf16_f32 v220, v204, v205
    v_cvt_pk_bf16_f32 v221, v206, v207
    v_mfma_f32_16x16x32_bf16 v[36:39], v[240:243], v[52:55], 0
    v_cvt_pk_bf16_f32 v222, v208, v209
    v_cvt_pk_bf16_f32 v223, v210, v211
    s_waitcnt lgkmcnt(5)
    s_nop 0
    v_mfma_f32_16x16x32_bf16 v[24:27], v[96:99], v[56:59], v[24:27]
    ds_read_b128 v[48:51], v4 offset:416
    v_mfma_f32_16x16x32_bf16 v[28:31], v[128:131], v[56:59], v[28:31]
    v_mfma_f32_16x16x32_bf16 v[24:27], v[220:223], v[164:167], v[24:27]
    v_mfma_f32_16x16x32_bf16 v[28:31], v[220:223], v[168:171], v[28:31]
    v_mfma_f32_16x16x32_bf16 v[32:35], v[220:223], v[172:175], v[32:35]
    v_mfma_f32_16x16x32_bf16 v[32:35], v[160:163], v[56:59], v[32:35]
    v_mfma_f32_16x16x32_bf16 v[212:215], v[84:87], v[236:239], 0
    v_mfma_f32_16x16x32_bf16 v[216:219], v[84:87], v[232:235], 0
    v_mfma_f32_16x16x32_bf16 v[40:43], v[240:243], v[56:59], 0
    ds_read_b128 v[88:91], v4 offset:992
    ds_read_b128 v[92:95], v4 offset:976
    s_waitcnt lgkmcnt(7)
    s_nop 0
    v_mfma_f32_16x16x32_bf16 v[28:31], v[96:99], v[60:63], v[28:31]
    ds_read_b128 v[52:55], v4 offset:928
    v_mfma_f32_16x16x32_bf16 v[32:35], v[128:131], v[60:63], v[32:35]
    v_mfma_f32_16x16x32_bf16 v[36:39], v[160:163], v[60:63], v[36:39]
    v_cvt_pk_bf16_f32 v244, v212, v213
    v_cvt_pk_bf16_f32 v245, v214, v215
    v_mfma_f32_16x16x32_bf16 v[44:47], v[240:243], v[60:63], 0
    v_cvt_pk_bf16_f32 v246, v216, v217
    v_cvt_pk_bf16_f32 v247, v218, v219
    s_waitcnt lgkmcnt(7)
    s_nop 0
    v_mfma_f32_16x16x32_bf16 v[32:35], v[96:99], v[64:67], v[32:35]
    ds_read_b128 v[56:59], v4 offset:1440
    v_mfma_f32_16x16x32_bf16 v[36:39], v[128:131], v[64:67], v[36:39]
    v_mfma_f32_16x16x32_bf16 v[24:27], v[244:247], v[176:179], v[24:27]
    v_mfma_f32_16x16x32_bf16 v[28:31], v[244:247], v[180:183], v[28:31]
    v_mfma_f32_16x16x32_bf16 v[32:35], v[244:247], v[184:187], v[32:35]
    v_mfma_f32_16x16x32_bf16 v[40:43], v[160:163], v[64:67], v[40:43]
    v_mfma_f32_16x16x32_bf16 v[204:207], v[80:83], v[228:231], 0
    v_mfma_f32_16x16x32_bf16 v[208:211], v[84:87], v[224:227], 0
    s_waitcnt lgkmcnt(7)
    v_mfma_f32_16x16x32_bf16 v[36:39], v[96:99], v[68:71], v[36:39]
    ds_read_b128 v[60:63], v4 offset:1952
    v_mfma_f32_16x16x32_bf16 v[40:43], v[128:131], v[68:71], v[40:43]
    v_mfma_f32_16x16x32_bf16 v[44:47], v[160:163], v[68:71], v[44:47]
    s_waitcnt lgkmcnt(7)
    v_mfma_f32_16x16x32_bf16 v[40:43], v[96:99], v[72:75], v[40:43]
    ds_read_b128 v[64:67], v4 offset:2464
    v_cvt_pk_bf16_f32 v220, v204, v205
    v_cvt_pk_bf16_f32 v221, v206, v207
    v_mfma_f32_16x16x32_bf16 v[44:47], v[128:131], v[72:75], v[44:47]
    v_cvt_pk_bf16_f32 v222, v208, v209
    v_cvt_pk_bf16_f32 v223, v210, v211
    s_waitcnt lgkmcnt(7)
    v_mfma_f32_16x16x32_bf16 v[44:47], v[96:99], v[76:79], v[44:47]
    ds_read_b128 v[68:71], v4 offset:2976
    s_waitcnt lgkmcnt(7)
    v_mfma_f32_16x16x32_bf16 v[16:19], v[100:103], v[48:51], v[16:19]
    ds_read_b128 v[72:75], v4 offset:3488
    v_mfma_f32_16x16x32_bf16 v[32:35], v[220:223], v[188:191], v[32:35]
    v_mfma_f32_16x16x32_bf16 v[36:39], v[220:223], v[192:195], v[36:39]
    v_mfma_f32_16x16x32_bf16 v[40:43], v[220:223], v[196:199], v[40:43]
    v_mfma_f32_16x16x32_bf16 v[44:47], v[220:223], v[200:203], v[44:47]
    v_mfma_f32_16x16x32_bf16 v[20:23], v[132:135], v[48:51], v[20:23]
    s_waitcnt lgkmcnt(6)
    v_mfma_f32_16x16x32_bf16 v[212:215], v[88:91], v[236:239], 0
    v_mfma_f32_16x16x32_bf16 v[216:219], v[88:91], v[232:235], 0
    s_waitcnt lgkmcnt(5)
    v_mfma_f32_16x16x32_bf16 v[20:23], v[100:103], v[52:55], v[20:23]
    ds_read_b128 v[76:79], v4 offset:4000
    v_mfma_f32_16x16x32_bf16 v[24:27], v[132:135], v[52:55], v[24:27]
    s_waitcnt lgkmcnt(5)
    v_mfma_f32_16x16x32_bf16 v[24:27], v[100:103], v[56:59], v[24:27]
    ds_read_b128 v[48:51], v4 offset:352
    v_mfma_f32_16x16x32_bf16 v[28:31], v[132:135], v[56:59], v[28:31]
    v_cvt_pk_bf16_f32 v244, v212, v213
    v_cvt_pk_bf16_f32 v245, v214, v215
    s_waitcnt lgkmcnt(5)
    v_mfma_f32_16x16x32_bf16 v[28:31], v[100:103], v[60:63], v[28:31]
    ds_read_b128 v[52:55], v4 offset:864
    v_cvt_pk_bf16_f32 v246, v216, v217
    v_cvt_pk_bf16_f32 v247, v218, v219
    v_mfma_f32_16x16x32_bf16 v[32:35], v[132:135], v[60:63], v[32:35]
    s_waitcnt lgkmcnt(5)
    s_nop 0
    v_mfma_f32_16x16x32_bf16 v[32:35], v[100:103], v[64:67], v[32:35]
    ds_read_b128 v[56:59], v4 offset:1376
    v_mfma_f32_16x16x32_bf16 v[28:31], v[244:247], v[164:167], v[28:31]
    v_mfma_f32_16x16x32_bf16 v[32:35], v[244:247], v[168:171], v[32:35]
    v_mfma_f32_16x16x32_bf16 v[36:39], v[244:247], v[172:175], v[36:39]
    v_mfma_f32_16x16x32_bf16 v[36:39], v[132:135], v[64:67], v[36:39]
    v_mfma_f32_16x16x32_bf16 v[204:207], v[92:95], v[236:239], 0
    v_mfma_f32_16x16x32_bf16 v[208:211], v[92:95], v[232:235], 0
    s_waitcnt lgkmcnt(5)
    v_mfma_f32_16x16x32_bf16 v[36:39], v[100:103], v[68:71], v[36:39]
    ds_read_b128 v[60:63], v4 offset:1888
    ds_read_b128 v[80:83], v4 offset:1504
    ds_read_b128 v[84:87], v4 offset:1488
    v_mfma_f32_16x16x32_bf16 v[40:43], v[132:135], v[68:71], v[40:43]
    s_waitcnt lgkmcnt(7)
    v_mfma_f32_16x16x32_bf16 v[40:43], v[100:103], v[72:75], v[40:43]
    ds_read_b128 v[64:67], v4 offset:2400
    v_mfma_f32_16x16x32_bf16 v[44:47], v[132:135], v[72:75], v[44:47]
    v_cvt_pk_bf16_f32 v220, v204, v205
    v_cvt_pk_bf16_f32 v221, v206, v207
    s_waitcnt lgkmcnt(7)
    v_mfma_f32_16x16x32_bf16 v[44:47], v[100:103], v[76:79], v[44:47]
    ds_read_b128 v[68:71], v4 offset:2912
    v_cvt_pk_bf16_f32 v222, v208, v209
    v_cvt_pk_bf16_f32 v223, v210, v211
    s_waitcnt lgkmcnt(7)
    v_mfma_f32_16x16x32_bf16 v[16:19], v[104:107], v[48:51], v[16:19]
    ds_read_b128 v[72:75], v4 offset:3424
    v_mfma_f32_16x16x32_bf16 v[20:23], v[136:139], v[48:51], v[20:23]
    v_mfma_f32_16x16x32_bf16 v[28:31], v[220:223], v[176:179], v[28:31]
    v_mfma_f32_16x16x32_bf16 v[32:35], v[220:223], v[180:183], v[32:35]
    v_mfma_f32_16x16x32_bf16 v[36:39], v[220:223], v[184:187], v[36:39]
    s_waitcnt lgkmcnt(7)
    s_nop 0
    v_mfma_f32_16x16x32_bf16 v[20:23], v[104:107], v[52:55], v[20:23]
    ds_read_b128 v[76:79], v4 offset:3936
    v_mfma_f32_16x16x32_bf16 v[212:215], v[88:91], v[228:231], 0
    v_mfma_f32_16x16x32_bf16 v[216:219], v[92:95], v[224:227], 0
    v_mfma_f32_16x16x32_bf16 v[24:27], v[136:139], v[52:55], v[24:27]
    s_waitcnt lgkmcnt(7)
    v_mfma_f32_16x16x32_bf16 v[24:27], v[104:107], v[56:59], v[24:27]
    ds_read_b128 v[48:51], v4 offset:288
    v_mfma_f32_16x16x32_bf16 v[28:31], v[136:139], v[56:59], v[28:31]
    s_waitcnt lgkmcnt(7)
    v_mfma_f32_16x16x32_bf16 v[28:31], v[104:107], v[60:63], v[28:31]
    ds_read_b128 v[52:55], v4 offset:800
    v_cvt_pk_bf16_f32 v244, v212, v213
    v_cvt_pk_bf16_f32 v245, v214, v215
    v_mfma_f32_16x16x32_bf16 v[32:35], v[136:139], v[60:63], v[32:35]
    v_cvt_pk_bf16_f32 v246, v216, v217
    v_cvt_pk_bf16_f32 v247, v218, v219
    s_waitcnt lgkmcnt(5)
    v_mfma_f32_16x16x32_bf16 v[32:35], v[104:107], v[64:67], v[32:35]
    ds_read_b128 v[56:59], v4 offset:1312
    v_mfma_f32_16x16x32_bf16 v[36:39], v[136:139], v[64:67], v[36:39]
    v_mfma_f32_16x16x32_bf16 v[36:39], v[244:247], v[188:191], v[36:39]
    v_mfma_f32_16x16x32_bf16 v[40:43], v[244:247], v[192:195], v[40:43]
    v_mfma_f32_16x16x32_bf16 v[44:47], v[244:247], v[196:199], v[44:47]
    s_waitcnt lgkmcnt(5)
    v_mfma_f32_16x16x32_bf16 v[36:39], v[104:107], v[68:71], v[36:39]
    ds_read_b128 v[60:63], v4 offset:1824
    v_mfma_f32_16x16x32_bf16 v[204:207], v[80:83], v[236:239], 0
    v_mfma_f32_16x16x32_bf16 v[208:211], v[80:83], v[232:235], 0
    v_mfma_f32_16x16x32_bf16 v[40:43], v[136:139], v[68:71], v[40:43]
    s_waitcnt lgkmcnt(5)
    v_mfma_f32_16x16x32_bf16 v[40:43], v[104:107], v[72:75], v[40:43]
    ds_read_b128 v[64:67], v4 offset:2336
    v_mfma_f32_16x16x32_bf16 v[44:47], v[136:139], v[72:75], v[44:47]
    s_waitcnt lgkmcnt(5)
    v_mfma_f32_16x16x32_bf16 v[44:47], v[104:107], v[76:79], v[44:47]
    ds_read_b128 v[68:71], v4 offset:2848
    v_cvt_pk_bf16_f32 v220, v204, v205
    v_cvt_pk_bf16_f32 v221, v206, v207
    s_waitcnt lgkmcnt(5)
    v_mfma_f32_16x16x32_bf16 v[16:19], v[108:111], v[48:51], v[16:19]
    ds_read_b128 v[72:75], v4 offset:3360
    v_cvt_pk_bf16_f32 v222, v208, v209
    v_cvt_pk_bf16_f32 v223, v210, v211
    v_mfma_f32_16x16x32_bf16 v[20:23], v[140:143], v[48:51], v[20:23]
    s_waitcnt lgkmcnt(5)
    v_mfma_f32_16x16x32_bf16 v[20:23], v[108:111], v[52:55], v[20:23]
    ds_read_b128 v[76:79], v4 offset:3872
    v_mfma_f32_16x16x32_bf16 v[32:35], v[220:223], v[164:167], v[32:35]
    v_mfma_f32_16x16x32_bf16 v[36:39], v[220:223], v[168:171], v[36:39]
    v_mfma_f32_16x16x32_bf16 v[40:43], v[220:223], v[172:175], v[40:43]
    v_mfma_f32_16x16x32_bf16 v[24:27], v[140:143], v[52:55], v[24:27]
    v_mfma_f32_16x16x32_bf16 v[212:215], v[84:87], v[236:239], 0
    v_mfma_f32_16x16x32_bf16 v[216:219], v[84:87], v[232:235], 0
    s_waitcnt lgkmcnt(5)
    v_mfma_f32_16x16x32_bf16 v[24:27], v[108:111], v[56:59], v[24:27]
    ds_read_b128 v[48:51], v4 offset:224
    ds_read_b128 v[88:91], v4 offset:2016
    ds_read_b128 v[92:95], v4 offset:2000
    v_mfma_f32_16x16x32_bf16 v[28:31], v[140:143], v[56:59], v[28:31]
    s_waitcnt lgkmcnt(7)
    v_mfma_f32_16x16x32_bf16 v[28:31], v[108:111], v[60:63], v[28:31]
    ds_read_b128 v[52:55], v4 offset:736
    v_mfma_f32_16x16x32_bf16 v[32:35], v[140:143], v[60:63], v[32:35]
    v_cvt_pk_bf16_f32 v244, v212, v213
    v_cvt_pk_bf16_f32 v245, v214, v215
    s_waitcnt lgkmcnt(7)
    v_mfma_f32_16x16x32_bf16 v[32:35], v[108:111], v[64:67], v[32:35]
    ds_read_b128 v[56:59], v4 offset:1248
    v_cvt_pk_bf16_f32 v246, v216, v217
    v_cvt_pk_bf16_f32 v247, v218, v219
    v_mfma_f32_16x16x32_bf16 v[36:39], v[140:143], v[64:67], v[36:39]
    s_waitcnt lgkmcnt(7)
    v_mfma_f32_16x16x32_bf16 v[36:39], v[108:111], v[68:71], v[36:39]
    ds_read_b128 v[60:63], v4 offset:1760
    v_mfma_f32_16x16x32_bf16 v[32:35], v[244:247], v[176:179], v[32:35]
    v_mfma_f32_16x16x32_bf16 v[36:39], v[244:247], v[180:183], v[36:39]
    v_mfma_f32_16x16x32_bf16 v[40:43], v[244:247], v[184:187], v[40:43]
    v_mfma_f32_16x16x32_bf16 v[40:43], v[140:143], v[68:71], v[40:43]
    v_mfma_f32_16x16x32_bf16 v[204:207], v[80:83], v[228:231], 0
    v_mfma_f32_16x16x32_bf16 v[208:211], v[84:87], v[224:227], 0
    s_waitcnt lgkmcnt(7)
    s_nop 0
    v_mfma_f32_16x16x32_bf16 v[40:43], v[108:111], v[72:75], v[40:43]
    ds_read_b128 v[64:67], v4 offset:2272
    v_mfma_f32_16x16x32_bf16 v[44:47], v[140:143], v[72:75], v[44:47]
    s_waitcnt lgkmcnt(7)
    v_mfma_f32_16x16x32_bf16 v[44:47], v[108:111], v[76:79], v[44:47]
    ds_read_b128 v[68:71], v4 offset:2784
    s_waitcnt lgkmcnt(7)
    v_mfma_f32_16x16x32_bf16 v[16:19], v[112:115], v[48:51], v[16:19]
    ds_read_b128 v[72:75], v4 offset:3296
    v_cvt_pk_bf16_f32 v220, v204, v205
    v_cvt_pk_bf16_f32 v221, v206, v207
    v_mfma_f32_16x16x32_bf16 v[20:23], v[144:147], v[48:51], v[20:23]
    v_cvt_pk_bf16_f32 v222, v208, v209
    v_cvt_pk_bf16_f32 v223, v210, v211
    s_waitcnt lgkmcnt(5)
    v_mfma_f32_16x16x32_bf16 v[20:23], v[112:115], v[52:55], v[20:23]
    ds_read_b128 v[76:79], v4 offset:3808
    v_mfma_f32_16x16x32_bf16 v[24:27], v[144:147], v[52:55], v[24:27]
    v_mfma_f32_16x16x32_bf16 v[40:43], v[220:223], v[188:191], v[40:43]
    v_mfma_f32_16x16x32_bf16 v[44:47], v[220:223], v[192:195], v[44:47]
    s_waitcnt lgkmcnt(5)
    v_mfma_f32_16x16x32_bf16 v[24:27], v[112:115], v[56:59], v[24:27]
    ds_read_b128 v[48:51], v4 offset:160
    v_mfma_f32_16x16x32_bf16 v[212:215], v[88:91], v[236:239], 0
    v_mfma_f32_16x16x32_bf16 v[216:219], v[88:91], v[232:235], 0
    v_mfma_f32_16x16x32_bf16 v[28:31], v[144:147], v[56:59], v[28:31]
    s_waitcnt lgkmcnt(5)
    v_mfma_f32_16x16x32_bf16 v[28:31], v[112:115], v[60:63], v[28:31]
    ds_read_b128 v[52:55], v4 offset:672
    v_mfma_f32_16x16x32_bf16 v[32:35], v[144:147], v[60:63], v[32:35]
    s_waitcnt lgkmcnt(5)
    v_mfma_f32_16x16x32_bf16 v[32:35], v[112:115], v[64:67], v[32:35]
    ds_read_b128 v[56:59], v4 offset:1184
    v_cvt_pk_bf16_f32 v244, v212, v213
    v_cvt_pk_bf16_f32 v245, v214, v215
    v_mfma_f32_16x16x32_bf16 v[36:39], v[144:147], v[64:67], v[36:39]
    v_cvt_pk_bf16_f32 v246, v216, v217
    v_cvt_pk_bf16_f32 v247, v218, v219
    s_waitcnt lgkmcnt(5)
    v_mfma_f32_16x16x32_bf16 v[36:39], v[112:115], v[68:71], v[36:39]
    ds_read_b128 v[60:63], v4 offset:1696
    v_mfma_f32_16x16x32_bf16 v[40:43], v[144:147], v[68:71], v[40:43]
    v_mfma_f32_16x16x32_bf16 v[36:39], v[244:247], v[164:167], v[36:39]
    v_mfma_f32_16x16x32_bf16 v[40:43], v[244:247], v[168:171], v[40:43]
    v_mfma_f32_16x16x32_bf16 v[44:47], v[244:247], v[172:175], v[44:47]
    s_waitcnt lgkmcnt(5)
    v_mfma_f32_16x16x32_bf16 v[40:43], v[112:115], v[72:75], v[40:43]
    ds_read_b128 v[64:67], v4 offset:2208
    v_mfma_f32_16x16x32_bf16 v[204:207], v[92:95], v[236:239], 0
    v_mfma_f32_16x16x32_bf16 v[208:211], v[92:95], v[232:235], 0
    v_mfma_f32_16x16x32_bf16 v[44:47], v[144:147], v[72:75], v[44:47]
    ds_read_b128 v[80:83], v4 offset:2528
    ds_read_b128 v[84:87], v4 offset:2512
    s_waitcnt lgkmcnt(7)
    v_mfma_f32_16x16x32_bf16 v[44:47], v[112:115], v[76:79], v[44:47]
    ds_read_b128 v[68:71], v4 offset:2720
    s_waitcnt lgkmcnt(7)
    v_mfma_f32_16x16x32_bf16 v[16:19], v[116:119], v[48:51], v[16:19]
    ds_read_b128 v[72:75], v4 offset:3232
    v_mfma_f32_16x16x32_bf16 v[20:23], v[148:151], v[48:51], v[20:23]
    v_cvt_pk_bf16_f32 v220, v204, v205
    v_cvt_pk_bf16_f32 v221, v206, v207
    s_waitcnt lgkmcnt(7)
    v_mfma_f32_16x16x32_bf16 v[20:23], v[116:119], v[52:55], v[20:23]
    ds_read_b128 v[76:79], v4 offset:3744
    v_cvt_pk_bf16_f32 v222, v208, v209
    v_cvt_pk_bf16_f32 v223, v210, v211
    v_mfma_f32_16x16x32_bf16 v[24:27], v[148:151], v[52:55], v[24:27]
    s_waitcnt lgkmcnt(7)
    v_mfma_f32_16x16x32_bf16 v[24:27], v[116:119], v[56:59], v[24:27]
    ds_read_b128 v[48:51], v4 offset:96
    v_mfma_f32_16x16x32_bf16 v[36:39], v[220:223], v[176:179], v[36:39]
    v_mfma_f32_16x16x32_bf16 v[40:43], v[220:223], v[180:183], v[40:43]
    v_mfma_f32_16x16x32_bf16 v[44:47], v[220:223], v[184:187], v[44:47]
    v_mfma_f32_16x16x32_bf16 v[28:31], v[148:151], v[56:59], v[28:31]
    v_mfma_f32_16x16x32_bf16 v[212:215], v[88:91], v[228:231], 0
    v_mfma_f32_16x16x32_bf16 v[216:219], v[92:95], v[224:227], 0
    s_waitcnt lgkmcnt(7)
    v_mfma_f32_16x16x32_bf16 v[28:31], v[116:119], v[60:63], v[28:31]
    ds_read_b128 v[52:55], v4 offset:608
    v_mfma_f32_16x16x32_bf16 v[32:35], v[148:151], v[60:63], v[32:35]
    s_waitcnt lgkmcnt(7)
    v_mfma_f32_16x16x32_bf16 v[32:35], v[116:119], v[64:67], v[32:35]
L_pageA1:
    s_cbranch_execz L_warmA
    s_nop 0
    ds_read_b128 v[56:59], v4 offset:1120
    v_mfma_f32_16x16x32_bf16 v[36:39], v[148:151], v[64:67], v[36:39]
    v_cvt_pk_bf16_f32 v244, v212, v213
    v_cvt_pk_bf16_f32 v245, v214, v215
    s_waitcnt lgkmcnt(5)
    v_mfma_f32_16x16x32_bf16 v[36:39], v[116:119], v[68:71], v[36:39]
    ds_read_b128 v[60:63], v4 offset:1632
    v_cvt_pk_bf16_f32 v246, v216, v217
    v_cvt_pk_bf16_f32 v247, v218, v219
    v_mfma_f32_16x16x32_bf16 v[40:43], v[148:151], v[68:71], v[40:43]
    s_waitcnt lgkmcnt(5)
    v_mfma_f32_16x16x32_bf16 v[40:43], v[116:119], v[72:75], v[40:43]
    ds_read_b128 v[64:67], v4 offset:2144
    v_mfma_f32_16x16x32_bf16 v[44:47], v[244:247], v[188:191], v[44:47]
    v_mfma_f32_16x16x32_bf16 v[44:47], v[148:151], v[72:75], v[44:47]
    v_mfma_f32_16x16x32_bf16 v[204:207], v[80:83], v[236:239], 0
    v_mfma_f32_16x16x32_bf16 v[208:211], v[80:83], v[232:235], 0
    s_waitcnt lgkmcnt(5)
    v_mfma_f32_16x16x32_bf16 v[44:47], v[116:119], v[76:79], v[44:47]
    ds_read_b128 v[68:71], v4 offset:2656
    s_waitcnt lgkmcnt(5)
    v_mfma_f32_16x16x32_bf16 v[16:19], v[120:123], v[48:51], v[16:19]
    ds_read_b128 v[72:75], v4 offset:3168
    v_mfma_f32_16x16x32_bf16 v[20:23], v[152:155], v[48:51], v[20:23]
    s_waitcnt lgkmcnt(5)
    s_nop 0
    v_mfma_f32_16x16x32_bf16 v[20:23], v[120:123], v[52:55], v[20:23]
    ds_read_b128 v[76:79], v4 offset:3680
    v_cvt_pk_bf16_f32 v220, v204, v205
    v_cvt_pk_bf16_f32 v221, v206, v207
    v_mfma_f32_16x16x32_bf16 v[24:27], v[152:155], v[52:55], v[24:27]
    v_cvt_pk_bf16_f32 v222, v208, v209
    v_cvt_pk_bf16_f32 v223, v210, v211
    s_waitcnt lgkmcnt(5)
    v_mfma_f32_16x16x32_bf16 v[24:27], v[120:123], v[56:59], v[24:27]
    ds_read_b128 v[48:51], v4 offset:32
    v_mfma_f32_16x16x32_bf16 v[28:31], v[152:155], v[56:59], v[28:31]
    v_mfma_f32_16x16x32_bf16 v[40:43], v[220:223], v[164:167], v[40:43]
    v_mfma_f32_16x16x32_bf16 v[44:47], v[220:223], v[168:171], v[44:47]
    s_waitcnt lgkmcnt(5)
    v_mfma_f32_16x16x32_bf16 v[28:31], v[120:123], v[60:63], v[28:31]
    ds_read_b128 v[52:55], v4 offset:544
    v_mfma_f32_16x16x32_bf16 v[212:215], v[84:87], v[236:239], 0
    v_mfma_f32_16x16x32_bf16 v[216:219], v[84:87], v[232:235], 0
    v_mfma_f32_16x16x32_bf16 v[32:35], v[152:155], v[60:63], v[32:35]
    ds_read_b128 v[88:91], v4 offset:3040
    ds_read_b128 v[92:95], v4 offset:3024
    s_waitcnt lgkmcnt(7)
    v_mfma_f32_16x16x32_bf16 v[32:35], v[120:123], v[64:67], v[32:35]
    ds_read_b128 v[56:59], v4 offset:1056
    v_mfma_f32_16x16x32_bf16 v[36:39], v[152:155], v[64:67], v[36:39]
    s_waitcnt lgkmcnt(7)
    v_mfma_f32_16x16x32_bf16 v[36:39], v[120:123], v[68:71], v[36:39]
    ds_read_b128 v[60:63], v4 offset:1568
    v_cvt_pk_bf16_f32 v244, v212, v213
    v_cvt_pk_bf16_f32 v245, v214, v215
    v_mfma_f32_16x16x32_bf16 v[40:43], v[152:155], v[68:71], v[40:43]
    v_cvt_pk_bf16_f32 v246, v216, v217
    v_cvt_pk_bf16_f32 v247, v218, v219
    s_waitcnt lgkmcnt(7)
    s_nop 0
    v_mfma_f32_16x16x32_bf16 v[40:43], v[120:123], v[72:75], v[40:43]
    ds_read_b128 v[64:67], v4 offset:2080
    v_mfma_f32_16x16x32_bf16 v[44:47], v[152:155], v[72:75], v[44:47]
    v_mfma_f32_16x16x32_bf16 v[40:43], v[244:247], v[176:179], v[40:43]
    v_mfma_f32_16x16x32_bf16 v[44:47], v[244:247], v[180:183], v[44:47]
    s_waitcnt lgkmcnt(7)
    v_mfma_f32_16x16x32_bf16 v[44:47], v[120:123], v[76:79], v[44:47]
    ds_read_b128 v[68:71], v4 offset:2592
    s_waitcnt lgkmcnt(4)
    v_mfma_f32_16x16x32_bf16 v[204:207], v[88:91], v[236:239], 0
    v_mfma_f32_16x16x32_bf16 v[208:211], v[88:91], v[232:235], 0
    v_mfma_f32_16x16x32_bf16 v[16:19], v[124:127], v[48:51], v[16:19]
    ds_read_b128 v[72:75], v4 offset:3104
    v_mfma_f32_16x16x32_bf16 v[20:23], v[156:159], v[48:51], v[20:23]
    v_mfma_f32_16x16x32_bf16 v[20:23], v[124:127], v[52:55], v[20:23]
    ds_read_b128 v[76:79], v4 offset:3616
    v_mfma_f32_16x16x32_bf16 v[24:27], v[156:159], v[52:55], v[24:27]
    s_nop 0
    v_cvt_pk_bf16_f32 v220, v204, v205
    v_cvt_pk_bf16_f32 v221, v206, v207
    s_waitcnt lgkmcnt(5)
    v_mfma_f32_16x16x32_bf16 v[24:27], v[124:127], v[56:59], v[24:27]
    v_cvt_pk_bf16_f32 v222, v208, v209
    v_cvt_pk_bf16_f32 v223, v210, v211
    v_mfma_f32_16x16x32_bf16 v[28:31], v[156:159], v[56:59], v[28:31]
    s_waitcnt lgkmcnt(4)
    s_nop 0
    v_mfma_f32_16x16x32_bf16 v[28:31], v[124:127], v[60:63], v[28:31]
    v_mfma_f32_16x16x32_bf16 v[44:47], v[220:223], v[164:167], v[44:47]
    v_mfma_f32_16x16x32_bf16 v[32:35], v[156:159], v[60:63], v[32:35]
    v_mfma_f32_16x16x32_bf16 v[212:215], v[92:95], v[236:239], 0
    v_mfma_f32_16x16x32_bf16 v[216:219], v[92:95], v[232:235], 0
    s_waitcnt lgkmcnt(3)
    v_mfma_f32_16x16x32_bf16 v[32:35], v[124:127], v[64:67], v[32:35]
    v_mfma_f32_16x16x32_bf16 v[36:39], v[156:159], v[64:67], v[36:39]
    s_waitcnt lgkmcnt(2)
    v_mfma_f32_16x16x32_bf16 v[36:39], v[124:127], v[68:71], v[36:39]
    v_mfma_f32_16x16x32_bf16 v[40:43], v[156:159], v[68:71], v[40:43]
    s_nop 0
    v_cvt_pk_bf16_f32 v244, v212, v213
    v_cvt_pk_bf16_f32 v245, v214, v215
    s_waitcnt lgkmcnt(1)
    v_mfma_f32_16x16x32_bf16 v[40:43], v[124:127], v[72:75], v[40:43]
    v_cvt_pk_bf16_f32 v246, v216, v217
    v_cvt_pk_bf16_f32 v247, v218, v219
    v_mfma_f32_16x16x32_bf16 v[44:47], v[156:159], v[72:75], v[44:47]
    s_waitcnt lgkmcnt(0)
    v_mfma_f32_16x16x32_bf16 v[44:47], v[124:127], v[76:79], v[44:47]
    v_mfma_f32_16x16x32_bf16 v[44:47], v[244:247], v[176:179], v[44:47]
L_cend:
    s_setprio 3
    v_and_b32 v2, 15, v1
    v_lshlrev_b32 v2, 5, v2
    v_bfe_u32 v3, v1, 4, 1
    v_lshl_add_u32 v2, v3, 9, v2
    v_lshrrev_b32_e64 v3, 5, v1
    v_lshl_add_u32 v2, v3, 4, v2
    s_lshl_b32 s64, s63, 12
    s_add_u32 s64, s64, 6291456
    s_waitcnt lgkmcnt(0)
    v_cvt_pk_bf16_f32 v48, v16, v17
    v_cvt_pk_bf16_f32 v49, v18, v19
    v_cvt_pk_bf16_f32 v50, v20, v21
    v_cvt_pk_bf16_f32 v51, v22, v23
    v_cvt_pk_bf16_f32 v52, v24, v25
    v_cvt_pk_bf16_f32 v53, v26, v27
    v_cvt_pk_bf16_f32 v54, v28, v29
    v_cvt_pk_bf16_f32 v55, v30, v31
    v_cvt_pk_bf16_f32 v56, v32, v33
    v_cvt_pk_bf16_f32 v57, v34, v35
    v_cvt_pk_bf16_f32 v58, v36, v37
    v_cvt_pk_bf16_f32 v59, v38, v39
    v_cvt_pk_bf16_f32 v60, v40, v41
    v_cvt_pk_bf16_f32 v61, v42, v43
    v_cvt_pk_bf16_f32 v62, v44, v45
    v_cvt_pk_bf16_f32 v63, v46, v47
    v_permlane16_swap_b32 v48, v50
    v_permlane16_swap_b32 v49, v51
    buffer_store_dwordx4 v[48:51], v2, s[44:47], s64 offen offset:0 sc1
    v_permlane16_swap_b32 v52, v54
    v_permlane16_swap_b32 v53, v55
    buffer_store_dwordx4 v[52:55], v2, s[44:47], s64 offen offset:1024 sc1
    v_permlane16_swap_b32 v56, v58
    v_permlane16_swap_b32 v57, v59
    buffer_store_dwordx4 v[56:59], v2, s[44:47], s64 offen offset:2048 sc1
    v_permlane16_swap_b32 v60, v62
    v_permlane16_swap_b32 v61, v63
    buffer_store_dwordx4 v[60:63], v2, s[44:47], s64 offen offset:3072 sc1
    s_waitcnt vmcnt(0)
    s_mov_b64 s[28:29], 1
    s_atomic_add_x2 s[28:29], s[32:33], s49 glc
    s_waitcnt lgkmcnt(0)
    s_sub_u32 s28, s28, s34
    s_subb_u32 s29, s29, s35
    s_lshr_b32 s28, s28, 8
    s_or_b32 s28, s28, s29
    s_cbranch_scc1 L_slow31
L_back31:
    s_endpgm
    s_nop 0
L_ep:
    s_waitcnt lgkmcnt(0)
    s_load_dwordx2 s[34:35], s[32:33], 196608
    s_waitcnt lgkmcnt(0)
    s_add_u32 s34, s34, 0x7f4a7c15
    s_addc_u32 s35, s35, 0x9e3779b9
    s_mov_b32 s44, s32
    s_mov_b32 s45, s33
    s_mov_b32 s46, 16777216
    s_mov_b32 s47, 0x20000
    s_mov_b32 s72, 0
L_spin33:
    s_mov_b64 s[20:21], 0
    s_atomic_add_x2 s[20:21], s[32:33], 28672 glc
    s_add_u32 s72, s72, 1
    s_cmp_ge_u32 s72, 131072
    s_waitcnt lgkmcnt(0)
    s_cbranch_scc1 L_got33
    s_sub_u32 s20, s20, s34
    s_subb_u32 s21, s21, s35
    s_xor_b32 s20, s20, 16
    s_or_b32 s20, s20, s21
    s_cbranch_scc0 L_got33
    s_sleep 32
    s_cbranch_scc1 L_spin33
L_got33:
    s_mov_b32 s72, 0
L_spin34:
    s_mov_b64 s[20:21], 0
    s_atomic_add_x2 s[20:21], s[32:33], 20480 glc
    s_add_u32 s72, s72, 1
    s_cmp_ge_u32 s72, 131072
    s_waitcnt lgkmcnt(0)
    s_cbranch_scc1 L_got34
    s_sub_u32 s20, s20, s34
    s_subb_u32 s21, s21, s35
    s_xor_b32 s20, s20, 20
    s_or_b32 s20, s20, s21
    s_cbranch_scc0 L_got34
    s_sleep 16
    s_cbranch_scc1 L_spin34
L_got34:
    v_and_b32 v1, 63, v0
    v_lshlrev_b32 v2, 8, v1
    v_add_u32 v3, 20480, v2
    v_lshlrev_b32_e64 v4, 10, v1
    v_add_u32 v4, -4096, v4
    v_cmp_gt_u32 vcc, 32, v1
    s_nop 1
    v_cndmask_b32_e64 v3, v4, v3, vcc
    v_cndmask_b32 v6, 16, 20, vcc
    v_mov_b32 v7, s35
    v_add_co_u32 v6, vcc, s34, v6
    s_nop 1
    v_addc_co_u32 v7, vcc, 0, v7, vcc
    s_mov_b32 exec_hi, 0xffff
    s_mov_b32 s72, 0
L_epl:
    v_mov_b32 v4, 0
    v_mov_b32_e64 v5, 0
    buffer_atomic_add_x2 v[4:5], v3, s[44:47], 0 offen sc0 sc1
    s_add_u32 s72, s72, 1
    s_waitcnt vmcnt(0)
    v_cmp_ne_u64 vcc, v[4:5], v[6:7]
    s_nop 0
    s_cbranch_vccz L_epd
    s_sleep 16
    s_cmp_lt_u32 s72, 131072
    s_cbranch_scc1 L_epl
L_epd:
    s_atomic_swap_x2 s[34:35], s[32:33], 196608
    s_endpgm
    s_nop 0
L_slow10:
    s_mov_b32 s72, 0
L_ag11:
    s_sleep 2
    s_mov_b64 s[10:11], 1
    s_atomic_add_x2 s[10:11], s[32:33], s18 glc
    s_add_u32 s72, s72, 1
    s_cmp_ge_u32 s72, 131072
    s_waitcnt lgkmcnt(0)
    s_cbranch_scc1 L_agd11
    s_sub_u32 s10, s10, s34
    s_subb_u32 s11, s11, s35
    s_lshr_b32 s10, s10, 8
    s_or_b32 s10, s10, s11
    s_cbranch_scc1 L_ag11
L_agd11:
    s_branch L_back10
    s_nop 0
L_slow16:
    s_waitcnt lgkmcnt(0)
    s_mov_b64 s[8:9], 0
    s_atomic_add_x2 s[8:9], s[32:33], s74 glc
    s_branch L_back16
    s_nop 0
L_slow17:
    s_waitcnt lgkmcnt(0)
    s_sub_u32 s8, s8, s34
    s_subb_u32 s9, s9, s35
    s_xor_b32 s8, s8, 20
    s_or_b32 s8, s8, s9
    s_cbranch_scc0 L_got18
    s_mov_b32 s72, 0
L_spin18:
    s_mov_b64 s[8:9], 0
    s_atomic_add_x2 s[8:9], s[32:33], s74 glc
    s_add_u32 s72, s72, 1
    s_cmp_ge_u32 s72, 131072
    s_waitcnt lgkmcnt(0)
    s_cbranch_scc1 L_got18
    s_sub_u32 s8, s8, s34
    s_subb_u32 s9, s9, s35
    s_xor_b32 s8, s8, 20
    s_or_b32 s8, s8, s9
    s_cbranch_scc0 L_got18
    s_sleep 4
    s_cbranch_scc1 L_spin18
L_got18:
    s_branch L_back17
L_slow19:
    s_mov_b32 s72, 0
L_ag20:
    s_sleep 2
    s_mov_b64 s[12:13], 1
    s_atomic_add_x2 s[12:13], s[32:33], s25 glc
    s_add_u32 s72, s72, 1
    s_cmp_ge_u32 s72, 131072
    s_waitcnt lgkmcnt(0)
    s_cbranch_scc1 L_agd20
    s_sub_u32 s12, s12, s34
    s_subb_u32 s13, s13, s35
    s_lshr_b32 s12, s12, 8
    s_or_b32 s12, s12, s13
    s_cbranch_scc1 L_ag20
L_agd20:
    s_branch L_back19
    s_nop 0
L_slow28:
    s_atomic_swap_x2 s[34:35], s[32:33], s49
    s_branch L_back28
L_slow31:
    s_mov_b32 s72, 0
L_ag32:
    s_sleep 2
    s_mov_b64 s[28:29], 1
    s_atomic_add_x2 s[28:29], s[32:33], s49 glc
    s_add_u32 s72, s72, 1
    s_cmp_ge_u32 s72, 131072
    s_waitcnt lgkmcnt(0)
    s_cbranch_scc1 L_agd32
    s_sub_u32 s28, s28, s34
    s_subb_u32 s29, s29, s35
    s_lshr_b32 s28, s28, 8
    s_or_b32 s28, s28, s29
    s_cbranch_scc1 L_ag32
L_agd32:
    s_branch L_back31
    s_nop 0
L_codeend:
.section .rodata,"a"
.p2align 6
.amdhsa_kernel gated_mix__ssm_conv_s4d__linear_kernel_hedgehog__prompt_kernel
  .amdhsa_next_free_vgpr 256
  .amdhsa_next_free_sgpr 102
  .amdhsa_accum_offset 256
  .amdhsa_group_segment_fixed_size 0
  .amdhsa_kernarg_size 120
  .amdhsa_user_sgpr_count 2
  .amdhsa_user_sgpr_kernarg_segment_ptr 1
  .amdhsa_system_sgpr_workgroup_id_x 1
.end_amdhsa_kernel
```
